```python
import torch

def _softmax(x, axis=-1):
    return torch.softmax(x, dim=axis)
def _gelu(x):
    return torch.nn.functional.gelu(x, approximate="tanh")
def _silu(x):
    return torch.nn.functional.silu(x)
def _sigmoid(x):
    return torch.sigmoid(x)
def _layernorm(x, axis=-1, eps=1e-5):
    m = x.mean(dim=axis, keepdim=True)
    v = x.var(dim=axis, keepdim=True, unbiased=False)
    return (x - m) / torch.sqrt(v + eps)
def _scatter_add(tgt, idx, src, axis=0):
    return tgt.clone().index_add_(axis, idx, src)
def _segment_sum(src, seg, n):
    out = torch.zeros((n,) + src.shape[1:], dtype=src.dtype)
    return out.index_add_(0, seg, src)
def _pad(x, pw):
    flat = tuple(v for pair in reversed(pw) for v in pair)
    return torch.nn.functional.pad(x, flat)

kernel_name = 'recurrent_scan__gqa_block_cached__dense_activation_silu__decode'

def setup_inputs():

    _w = (lambda a: (lambda t: t.to(torch.bfloat16) if t.is_floating_point() else t)(torch.as_tensor(a)))
    def _A_setup():
        B, Sq, D = 1, 1, 512
        Hq, Hkv, Sk, Dh = 32, 32, 8192, 128
        assert Hq % Hkv == 0, (Hq, Hkv)
        return {
            "x": _w((lambda *s: torch.randn(*s, dtype=torch.bfloat16) * 0.05)(B, Sq, D)),
            "k_cache": _w((lambda *s: torch.randn(*s, dtype=torch.bfloat16) * 3.2)(B, Hkv, Sk, Dh)),
            "v_cache": _w((lambda *s: torch.randn(*s, dtype=torch.bfloat16) * 3.2)(B, Hkv, Sk, Dh)),
            "wq": _w((lambda *s: torch.randn(*s, dtype=torch.bfloat16) * 3.2)(D, Hq * Dh) * (D ** -0.5)),
            "wo": _w((lambda *s: torch.randn(*s, dtype=torch.bfloat16) * 3.2)(Hq * Dh, D) * ((Hq * Dh) ** -0.5)),
        }
    _A_in = _A_setup()

    def _B_setup():
        B, S, D, F = 1, 1, 512, 1376
        return {
            "x": _w((lambda *s: torch.randn(*s, dtype=torch.bfloat16) * 0.05)(B, S, D)),
            "w1": _w((lambda *s: torch.randn(*s, dtype=torch.bfloat16) * 3.2)(D, F) * (D ** -0.5)),
            "w2": _w((lambda *s: torch.randn(*s, dtype=torch.bfloat16) * 0.4)(F, D) * (F ** -0.5)),
        }
    _B_in = _B_setup()

    return {
        "A_x": _A_in["x"],
        "A_k_cache": _A_in["k_cache"],
        "A_v_cache": _A_in["v_cache"],
        "A_wq": _A_in["wq"],
        "A_wo": _A_in["wo"],
        "B_x": _B_in["x"],
        "B_w1": _B_in["w1"],
        "B_w2": _B_in["w2"],
    }

def reference(A_x, A_k_cache, A_v_cache, A_wq, A_wo, B_x, B_w1, B_w2):
    def _A_ref(x, k_cache, v_cache, wq, wo):
        B, Sq, D = x.shape
        Hq, Dh = 32, 128
        Hkv = k_cache.shape[1]
        rep = Hq // Hkv
        q = (lambda x, *d: x.permute(*d))((x @ wq).reshape(B, Sq, Hq, Dh), 0, 2, 1, 3)
        k = (lambda x, n, axis: torch.repeat_interleave(x, n, dim=axis))(k_cache, rep, axis=1)
        v = (lambda x, n, axis: torch.repeat_interleave(x, n, dim=axis))(v_cache, rep, axis=1)
        scores = torch.einsum("bhqd,bhkd->bhqk", q, k) * (Dh ** -0.5)
        p = _softmax(scores, axis=-1)
        o = torch.einsum("bhqk,bhkd->bhqd", p, v)
        return (lambda x, *d: x.permute(*d))(o, 0, 2, 1, 3).reshape(B, Sq, Hq * Dh) @ wo

    def _B_ref(x, w1, w2):
        h = torch.einsum("bsd,df->bsf", x, w1)
        h = _silu(h)
        out = torch.einsum("bsf,fd->bsd", h, w2)
        return out

    x = A_x
    xn = _layernorm(x, axis=-1)
    s = _A_ref(xn, A_k_cache, A_v_cache, A_wq, A_wo)
    g = _silu(_B_ref(xn, B_w1, B_w2))
    return x + s * g
```

```asm
; @launch grid=(256,1,1) block=(256,1,1) lds=20480
.amdgcn_target "amdgcn-amd-amdhsa--gfx950"
.text
.globl recurrent_scan__gqa_block_cached__dense_activation_silu__decode_kernel
.p2align 8
.type recurrent_scan__gqa_block_cached__dense_activation_silu__decode_kernel,@function
recurrent_scan__gqa_block_cached__dense_activation_silu__decode_kernel:
    s_load_dwordx8 s[4:11], s[0:1], 0
    s_load_dwordx2 s[14:15], s[0:1], 80
    s_load_dwordx4 s[16:19], s[0:1], 48
    s_cmp_ge_u32 s2, 256
    s_cbranch_scc1 recurrent_scan__gqa_block_cached__dense_activation_silu__decode_kernel_end
    v_lshrrev_b32 v32, 6, v0
    v_and_b32 v1, 63, v0
    s_and_b32 s20, s2, 7
    v_readfirstlane_b32 s3, v32
    v_lshlrev_b32 v8, 4, v1
    s_lshl_b32 s20, s20, 2
    s_bfe_u32 s22, s2, 0x20003
    s_add_u32 s20, s20, s22
    s_lshr_b32 s21, s2, 5
    s_lshl_b32 s22, s20, 3
    s_add_u32 s22, s22, s21
    s_lshl_b32 s26, s22, 18
    s_lshl_b32 s64, s3, 12
    v_add_u32 v9, 16384, v8
    v_add_u32 v10, 32768, v8
    s_mov_b32 s34, 262144
    s_mov_b32 s35, 0x00020000
    s_waitcnt lgkmcnt(0)
    s_add_u32 s32, s6, s26
    s_addc_u32 s33, s7, 0
    buffer_load_dwordx4 v[64:67], v8, s[32:35], s64 offen offset:0 nt
    buffer_load_dwordx4 v[68:71], v8, s[32:35], s64 offen offset:1024 nt
    buffer_load_dwordx4 v[72:75], v8, s[32:35], s64 offen offset:2048 nt
    buffer_load_dwordx4 v[76:79], v8, s[32:35], s64 offen offset:3072 nt
    s_mov_b32 s28, s4
    s_mov_b32 s29, s5
    s_mov_b32 s30, 1024
    s_mov_b32 s31, 0x00020000
    v_lshrrev_b32 v3, 4, v1
    s_lshl_b32 s69, s21, 6
    s_lshl_b32 s25, s3, 4
    s_add_u32 s69, s69, s25
    v_lshlrev_b32 v35, 3, v3
    s_lshl_b32 s24, s69, 1
    buffer_load_dwordx4 v[128:131], v8, s[28:31], 0 offen
    buffer_load_dwordx2 v[132:133], v35, s[28:31], s24 offen
    buffer_load_dwordx4 v[80:83], v9, s[32:35], s64 offen offset:0 nt
    buffer_load_dwordx4 v[84:87], v9, s[32:35], s64 offen offset:1024 nt
    s_waitcnt vmcnt(7)
    buffer_load_dwordx4 v[88:91], v9, s[32:35], s64 offen offset:2048 nt
    s_waitcnt vmcnt(7)
    buffer_load_dwordx4 v[92:95], v9, s[32:35], s64 offen offset:3072 nt
    s_load_dwordx2 s[12:13], s[0:1], 32
    s_load_dwordx2 s[70:71], s[0:1], 64
    s_load_dword s72, s[14:15], 0
    v_and_b32 v2, 15, v1
    v_lshlrev_b32 v32, 4, v2
    v_lshl_add_u32 v188, v3, 15, v32
    s_lshl_b32 s23, s69, 13
    s_lshl_b32 s25, s20, 8
    s_add_u32 s23, s23, s25
    s_sub_u32 s27, 0x400000, s23
    s_add_u32 s40, s10, s23
    s_addc_u32 s41, s11, 0
    s_mov_b32 s42, s27
    s_mov_b32 s43, 0x00020000
    s_mov_b32 s68, 0
    buffer_load_dwordx4 v[136:139], v188, s[40:43], s68 offen
    s_mov_b32 s68, 8192
    buffer_load_dwordx4 v[140:143], v188, s[40:43], s68 offen
    s_mov_b32 s68, 16384
    buffer_load_dwordx4 v[144:147], v188, s[40:43], s68 offen
    s_mov_b32 s68, 24576
    buffer_load_dwordx4 v[148:151], v188, s[40:43], s68 offen
    s_add_u32 s36, s8, s26
    s_addc_u32 s37, s9, 0
    s_mov_b32 s38, 262144
    s_mov_b32 s39, 0x00020000
    s_waitcnt vmcnt(7)
    buffer_load_dwordx4 a[0:3], v8, s[36:39], s64 offen offset:0 nt
    s_waitcnt vmcnt(7)
    buffer_load_dwordx4 a[4:7], v8, s[36:39], s64 offen offset:1024 nt
    s_waitcnt vmcnt(7)
    buffer_load_dwordx4 a[8:11], v8, s[36:39], s64 offen offset:2048 nt
    s_waitcnt vmcnt(7)
    buffer_load_dwordx4 a[12:15], v8, s[36:39], s64 offen offset:3072 nt
    v_add_u32 v11, 49152, v8
    s_add_u32 s65, s64, 65536
    s_add_u32 s66, s64, 131072
    s_add_u32 s67, s64, 196608
    v_lshl_add_u32 v63, v3, 15, v32
    v_mul_u32_u24 v189, 11008, v3
    v_add_u32 v189, v189, v32
    s_mul_i32 s23, s69, 2752
    s_add_u32 s23, s23, s25
    s_sub_u32 s27, 1409024, s23
    s_cmp_lt_u32 s20, 11
    s_cselect_b32 s27, s27, 0
    s_cselect_b32 s23, s23, 0
    s_add_u32 s48, s16, s23
    s_addc_u32 s49, s17, 0
    s_mov_b32 s50, s27
    s_mov_b32 s51, 0x00020000
    s_mov_b32 s68, 0
    buffer_load_dwordx4 v[152:155], v189, s[48:51], s68 offen
    s_mov_b32 s68, 2752
    buffer_load_dwordx4 v[156:159], v189, s[48:51], s68 offen
    s_mov_b32 s68, 5504
    buffer_load_dwordx4 v[160:163], v189, s[48:51], s68 offen
    s_mov_b32 s68, 8256
    buffer_load_dwordx4 v[164:167], v189, s[48:51], s68 offen
    s_waitcnt lgkmcnt(0)
    s_add_u32 s23, s20, 21
    s_and_b32 s23, s23, 31
    s_lshl_b32 s23, s23, 3
    s_add_u32 s23, s23, s21
    s_cmp_lt_u32 s23, 172
    s_cselect_b32 s25, 1, 0
    s_cselect_b32 s23, s23, 0
    s_lshl_b32 s26, s23, 3
    s_add_u32 s26, s26, s3
    s_lshl_b32 s26, s26, 10
    s_mul_i32 s27, s25, 5120
    s_add_u32 s52, s18, s26
    s_addc_u32 s53, s19, 0
    s_mov_b32 s54, s27
    s_mov_b32 s55, 0x00020000
    s_lshl_b32 s26, s20, 17
    s_lshl_b32 s27, s3, 8
    s_add_u32 s26, s26, s27
    s_sub_u32 s27, 0x400000, s26
    s_add_u32 s44, s12, s26
    s_addc_u32 s45, s13, 0
    s_mov_b32 s46, s27
    s_mov_b32 s47, 0x00020000
    v_and_b32 v32, 1, v2
    v_lshlrev_b32 v32, 4, v32
    v_mov_b32 v33, 0xffff
    v_lshlrev_b32 v33, v32, v33
    v_bfe_u32 v32, v2, 1, 2
    v_cmp_eq_u32 vcc, 0, v32
    s_nop 1
    v_cndmask_b32 v4, 0, v33, vcc
    v_cmp_eq_u32 vcc, 1, v32
    s_nop 1
    v_cndmask_b32 v5, 0, v33, vcc
    v_cmp_eq_u32 vcc, 2, v32
    s_nop 1
    v_cndmask_b32 v6, 0, v33, vcc
    v_cmp_eq_u32 vcc, 3, v32
    s_nop 1
    v_cndmask_b32 v7, 0, v33, vcc
    v_lshlrev_b32 v32, 16, v128
    v_and_b32 v33, 0xffff0000, v128
    v_lshlrev_b32 v34, 16, v129
    v_and_b32 v35, 0xffff0000, v129
    v_lshlrev_b32 v36, 16, v130
    v_and_b32 v37, 0xffff0000, v130
    v_lshlrev_b32 v38, 16, v131
    v_and_b32 v39, 0xffff0000, v131
    v_add_f32 v40, v32, v33
    v_add_f32 v40, v40, v34
    v_add_f32 v40, v40, v35
    v_add_f32 v40, v40, v36
    v_add_f32 v40, v40, v37
    v_add_f32 v40, v40, v38
    v_add_f32 v40, v40, v39
    s_nop 1
    v_add_f32_dpp v40, v40, v40 quad_perm:[1,0,3,2] row_mask:0xf bank_mask:0xf
    s_nop 1
    v_add_f32_dpp v40, v40, v40 quad_perm:[2,3,0,1] row_mask:0xf bank_mask:0xf
    s_nop 1
    v_add_f32_dpp v40, v40, v40 row_half_mirror row_mask:0xf bank_mask:0xf
    s_nop 1
    v_add_f32_dpp v40, v40, v40 row_mirror row_mask:0xf bank_mask:0xf
    s_waitcnt vmcnt(7)
    buffer_load_dwordx4 a[16:19], v9, s[36:39], s64 offen offset:0 nt
    v_mov_b32 v41, v40
    s_nop 1
    v_permlane16_swap_b32 v40, v41
    s_nop 0
    v_add_f32 v40, v40, v41
    v_mov_b32 v41, v40
    s_nop 1
    v_permlane32_swap_b32 v40, v41
    s_nop 0
    v_add_f32 v40, v40, v41
    v_mul_f32 v40, 0x3b000000, v40
    v_sub_f32 v32, v32, v40
    v_sub_f32 v33, v33, v40
    v_sub_f32 v34, v34, v40
    v_sub_f32 v35, v35, v40
    v_sub_f32 v36, v36, v40
    v_sub_f32 v37, v37, v40
    v_sub_f32 v38, v38, v40
    v_sub_f32 v39, v39, v40
    v_mul_f32 v42, v32, v32
    v_fmac_f32 v42, v33, v33
    v_fmac_f32 v42, v34, v34
    v_fmac_f32 v42, v35, v35
    v_fmac_f32 v42, v36, v36
    v_fmac_f32 v42, v37, v37
    v_fmac_f32 v42, v38, v38
    v_fmac_f32 v42, v39, v39
    s_nop 1
    v_add_f32_dpp v42, v42, v42 quad_perm:[1,0,3,2] row_mask:0xf bank_mask:0xf
    s_nop 1
    v_add_f32_dpp v42, v42, v42 quad_perm:[2,3,0,1] row_mask:0xf bank_mask:0xf
    s_nop 1
    v_add_f32_dpp v42, v42, v42 row_half_mirror row_mask:0xf bank_mask:0xf
    s_nop 1
    v_add_f32_dpp v42, v42, v42 row_mirror row_mask:0xf bank_mask:0xf
    v_mov_b32 v41, v42
    s_nop 1
    v_permlane16_swap_b32 v42, v41
    s_nop 0
    v_add_f32 v42, v42, v41
    s_waitcnt vmcnt(7)
    buffer_load_dwordx4 a[20:23], v9, s[36:39], s64 offen offset:1024 nt
    v_mov_b32 v41, v42
    s_nop 1
    v_permlane32_swap_b32 v42, v41
    s_nop 0
    v_add_f32 v42, v42, v41
    v_mul_f32 v42, 0x3b000000, v42
    v_cvt_pk_bf16_f32 v40, v40, v40
    v_lshlrev_b32 v40, 16, v40
    v_cvt_pk_bf16_f32 v42, v42, v42
    v_lshlrev_b32 v42, 16, v42
    v_add_f32 v42, 0x3727c5ac, v42
    v_cvt_pk_bf16_f32 v42, v42, v42
    v_lshlrev_b32 v42, 16, v42
    v_sqrt_f32 v42, v42
    s_nop 0
    v_cvt_pk_bf16_f32 v42, v42, v42
    v_lshlrev_b32 v42, 16, v42
    v_rcp_f32 v43, v42
    s_nop 0
    v_lshlrev_b32 v32, 16, v132
    v_and_b32 v33, 0xffff0000, v132
    v_sub_f32 v32, v32, v40
    v_cvt_pk_bf16_f32 v32, v32, v32
    v_lshlrev_b32 v32, 16, v32
    v_mul_f32 v34, v32, v43
    v_fma_f32 v35, -v34, v42, v32
    v_fma_f32 v34, v35, v43, v34
    v_sub_f32 v33, v33, v40
    v_cvt_pk_bf16_f32 v33, v33, v33
    v_lshlrev_b32 v33, 16, v33
    v_mul_f32 v36, v33, v43
    v_fma_f32 v37, -v36, v42, v33
    v_fma_f32 v36, v37, v43, v36
    v_cvt_pk_bf16_f32 v46, v34, v34
    v_cvt_pk_bf16_f32 v47, v36, v36
    v_lshlrev_b32 v32, 16, v133
    v_and_b32 v33, 0xffff0000, v133
    v_sub_f32 v32, v32, v40
    v_cvt_pk_bf16_f32 v32, v32, v32
    v_lshlrev_b32 v32, 16, v32
    s_waitcnt vmcnt(7)
    buffer_load_dwordx4 a[24:27], v9, s[36:39], s64 offen offset:2048 nt
    v_mul_f32 v34, v32, v43
    v_fma_f32 v35, -v34, v42, v32
    v_fma_f32 v34, v35, v43, v34
    v_sub_f32 v33, v33, v40
    v_cvt_pk_bf16_f32 v33, v33, v33
    v_lshlrev_b32 v33, 16, v33
    v_mul_f32 v36, v33, v43
    v_fma_f32 v37, -v36, v42, v33
    v_fma_f32 v36, v37, v43, v36
    v_cvt_pk_bf16_f32 v48, v34, v34
    v_cvt_pk_bf16_f32 v49, v36, v36
    v_and_b32 v20, v4, v46
    v_and_b32 v21, v5, v46
    v_and_b32 v22, v6, v46
    v_and_b32 v23, v7, v46
    v_and_b32 v24, v4, v47
    v_and_b32 v25, v5, v47
    v_and_b32 v26, v6, v47
    v_and_b32 v27, v7, v47
    v_mfma_f32_16x16x32_bf16 v[28:31], v[20:23], v[136:139], 0
    s_waitcnt vmcnt(3)
    v_mfma_f32_16x16x32_bf16 v[16:19], v[20:23], v[152:155], 0
    v_and_b32 v20, v4, v48
    v_and_b32 v21, v5, v48
    v_and_b32 v22, v6, v48
    v_and_b32 v23, v7, v48
    v_mfma_f32_16x16x32_bf16 v[28:31], v[24:27], v[140:143], v[28:31]
    s_waitcnt vmcnt(3)
    v_mfma_f32_16x16x32_bf16 v[16:19], v[24:27], v[156:159], v[16:19]
    v_and_b32 v24, v4, v49
    v_and_b32 v25, v5, v49
    v_and_b32 v26, v6, v49
    v_and_b32 v27, v7, v49
    v_mfma_f32_16x16x32_bf16 v[28:31], v[20:23], v[144:147], v[28:31]
    s_waitcnt vmcnt(3)
    v_mfma_f32_16x16x32_bf16 v[16:19], v[20:23], v[160:163], v[16:19]
    s_nop 1
    v_mfma_f32_16x16x32_bf16 v[28:31], v[24:27], v[148:151], v[28:31]
    s_waitcnt vmcnt(3)
    v_mfma_f32_16x16x32_bf16 v[16:19], v[24:27], v[164:167], v[16:19]
    buffer_load_dwordx4 a[28:31], v9, s[36:39], s64 offen offset:3072 nt
    v_and_b32 v38, 1, v3
    v_lshlrev_b32 v38, 4, v38
    v_lshl_add_u32 v38, v2, 5, v38
    s_lshl_b32 s26, s3, 9
    v_add_u32 v38, s26, v38
    s_lshl_b32 s26, s22, 10
    s_add_u32 s27, s26, 2097152
    s_add_u32 s26, s26, 2359296
    s_cmp_eq_u32 s3, 0
    s_cselect_b32 s26, s27, s26
    s_cselect_b32 s27, 1024, 0
    s_cselect_b32 s24, 0, 2048
    s_cmp_eq_u32 s3, 1
    s_cselect_b32 s68, 1024, 0
    s_cmp_lt_u32 s20, 11
    s_cselect_b32 s68, s68, 0
    s_add_u32 s27, s27, s68
    s_add_u32 s60, s14, s26
    s_addc_u32 s61, s15, 0
    s_mov_b32 s62, s27
    s_mov_b32 s63, 0x00020000
    ds_write_b128 v38, v[28:31] offset:0
    ds_write_b128 v38, v[16:19] offset:2048
    v_lshlrev_b32 v38, 3, v1
    v_add_u32 v38, s24, v38
    s_waitcnt lgkmcnt(0)
    s_barrier
    ds_read_b64 v[46:47], v38 offset:0
    ds_read_b64 v[48:49], v38 offset:512
    ds_read_b64 v[50:51], v38 offset:1024
    ds_read_b64 v[52:53], v38 offset:1536
    s_mul_i32 s73, s72, 0x9E3779B1
    s_add_u32 s73, s73, 0x7F4A7C15
    s_mul_i32 s74, s72, 0x85EBCA77
    s_add_u32 s74, s74, 0xC2B2AE3D
    s_waitcnt lgkmcnt(0)
    v_add_f32 v46, v46, v48
    v_add_f32 v47, v47, v49
    v_add_f32 v50, v50, v52
    v_add_f32 v51, v51, v53
    v_add_f32 v46, v46, v50
    v_add_f32 v48, v47, v51
    v_mov_b32 v47, s73
    v_mov_b32 v49, s74
    buffer_store_dwordx4 v[46:49], v8, s[60:63], 0 offen sc0 sc1
    buffer_load_dwordx4 v[168:171], v8, s[52:55], 0 offen
    s_movk_i32 s27, 4096
    buffer_load_dwordx4 v[172:175], v8, s[52:55], s27 offen
    buffer_load_dwordx4 v[96:99], v10, s[32:35], s64 offen offset:0 nt
    buffer_load_dwordx4 v[100:103], v10, s[32:35], s64 offen offset:1024 nt
    buffer_load_dwordx4 v[104:107], v10, s[32:35], s64 offen offset:2048 nt
    buffer_load_dwordx4 v[108:111], v10, s[32:35], s64 offen offset:3072 nt
    s_waitcnt vmcnt(7)
    buffer_load_dwordx4 v[112:115], v11, s[32:35], s64 offen offset:0 nt
    s_waitcnt vmcnt(7)
    buffer_load_dwordx4 v[116:119], v11, s[32:35], s64 offen offset:1024 nt
    s_waitcnt vmcnt(7)
    buffer_load_dwordx4 v[120:123], v11, s[32:35], s64 offen offset:2048 nt
    s_waitcnt vmcnt(7)
    buffer_load_dwordx4 v[124:127], v11, s[32:35], s64 offen offset:3072 nt
    s_waitcnt vmcnt(7)
    buffer_load_dwordx4 a[32:35], v10, s[36:39], s64 offen offset:0 nt
    s_waitcnt vmcnt(7)
    buffer_load_dwordx4 a[36:39], v10, s[36:39], s64 offen offset:1024 nt
    s_waitcnt vmcnt(7)
    buffer_load_dwordx4 a[40:43], v10, s[36:39], s64 offen offset:2048 nt
    s_waitcnt vmcnt(7)
    buffer_load_dwordx4 a[44:47], v10, s[36:39], s64 offen offset:3072 nt
    s_lshl_b32 s26, s20, 13
    s_lshl_b32 s27, s3, 11
    s_add_u32 s26, s26, s27
    s_add_u32 s26, s26, 2097152
    s_add_u32 s60, s14, s26
    s_addc_u32 s61, s15, 0
    s_mov_b32 s62, 2048
    s_mov_b32 s63, 0x00020000
    buffer_load_dwordx4 v[176:179], v8, s[60:63], 0 offen sc0 sc1
    buffer_load_dwordx4 v[180:183], v8, s[60:63], 0 offen offset:1024 sc0 sc1
    s_waitcnt vmcnt(7)
    buffer_load_dwordx4 a[48:51], v11, s[36:39], s64 offen offset:0 nt
    s_waitcnt vmcnt(7)
    buffer_load_dwordx4 a[52:55], v11, s[36:39], s64 offen offset:1024 nt
    s_waitcnt vmcnt(7)
    buffer_load_dwordx4 a[56:59], v11, s[36:39], s64 offen offset:2048 nt
    s_waitcnt vmcnt(7)
    buffer_load_dwordx4 a[60:63], v11, s[36:39], s64 offen offset:3072 nt
    s_waitcnt vmcnt(7)
    buffer_load_dwordx4 a[64:67], v8, s[36:39], s65 offen offset:0 nt
    s_waitcnt vmcnt(7)
    buffer_load_dwordx4 a[68:71], v8, s[36:39], s65 offen offset:1024 nt
    s_waitcnt vmcnt(7)
    buffer_load_dwordx4 a[72:75], v8, s[36:39], s65 offen offset:2048 nt
    s_waitcnt vmcnt(7)
    buffer_load_dwordx4 a[76:79], v8, s[36:39], s65 offen offset:3072 nt
    s_waitcnt vmcnt(7)
    buffer_load_dwordx4 a[80:83], v9, s[36:39], s65 offen offset:0 nt
    s_waitcnt vmcnt(7)
    buffer_load_dwordx4 a[84:87], v9, s[36:39], s65 offen offset:1024 nt
    s_waitcnt vmcnt(7)
    buffer_load_dwordx4 a[88:91], v9, s[36:39], s65 offen offset:2048 nt
    s_waitcnt vmcnt(7)
    buffer_load_dwordx4 a[92:95], v9, s[36:39], s65 offen offset:3072 nt
    s_mov_b32 s24, 0
recurrent_scan__gqa_block_cached__dense_activation_silu__decode_kernel_qchk:
    v_xor_b32 v32, s73, v177
    v_xor_b32 v33, s74, v179
    v_xor_b32 v34, s73, v181
    v_xor_b32 v35, s74, v183
    v_or3_b32 v32, v32, v33, v34
    v_or_b32 v32, v32, v35
    v_cmp_ne_u32 vcc, 0, v32
    s_add_u32 s24, s24, 1
    s_cbranch_vccz recurrent_scan__gqa_block_cached__dense_activation_silu__decode_kernel_qok
    s_cmp_ge_u32 s24, 0x40000
    s_cbranch_scc1 recurrent_scan__gqa_block_cached__dense_activation_silu__decode_kernel_qok
    buffer_load_dwordx4 v[176:179], v8, s[60:63], 0 offen sc0 sc1
    buffer_load_dwordx4 v[180:183], v8, s[60:63], 0 offen offset:1024 sc0 sc1
    s_waitcnt vmcnt(0)
    s_branch recurrent_scan__gqa_block_cached__dense_activation_silu__decode_kernel_qchk
recurrent_scan__gqa_block_cached__dense_activation_silu__decode_kernel_qok:
    v_add_f32 v32, v176, v180
    v_add_f32 v33, v178, v182
    v_lshlrev_b32 v38, 3, v1
    s_lshl_b32 s26, s3, 9
    v_add_u32 v34, s26, v38
    ds_write_b64 v34, v[32:33] offset:6144
    v_bfe_u32 v190, v1, 2, 3
    v_lshlrev_b32 v190, 10, v190
    v_and_b32 v35, 3, v1
    v_lshl_add_u32 v190, v35, 4, v190
    s_lshr_b32 s26, s23, 4
    s_lshl_b32 s26, s26, 13
    s_and_b32 s27, s23, 15
    s_lshl_b32 s27, s27, 6
    s_add_u32 s26, s26, s27
    s_add_u32 s26, s26, 2359296
    s_mul_i32 s27, s25, 8192
    s_add_u32 s48, s14, s26
    s_addc_u32 s49, s15, 0
    s_mov_b32 s50, s27
    s_mov_b32 s51, 0x00020000
    buffer_load_dwordx4 v[184:187], v190, s[48:51], 0 offen sc0 sc1
    s_waitcnt lgkmcnt(0)
    s_barrier
    ds_read_b64 v[46:47], v38 offset:6144
    ds_read_b64 v[48:49], v38 offset:6656
    ds_read_b64 v[50:51], v38 offset:7168
    ds_read_b64 v[52:53], v38 offset:7680
    v_lshlrev_b32 v34, 2, v1
    s_lshl_b32 s26, s3, 8
    v_add_u32 v34, s26, v34
    v_lshlrev_b32 v35, 4, v2
    v_add_u32 v35, s26, v35
    s_waitcnt lgkmcnt(0)
    v_add_f32 v46, v46, v48
    v_add_f32 v47, v47, v49
    v_add_f32 v50, v50, v52
    v_add_f32 v51, v51, v53
    v_add_f32 v46, v46, v50
    v_add_f32 v47, v47, v51
    v_cvt_pk_bf16_f32 v46, v46, v47
    ds_write_b32 v34, v46 offset:4096
    s_waitcnt lgkmcnt(0)
    ds_read_b128 v[14:17], v35 offset:4096
    s_waitcnt lgkmcnt(0)
    v_dot2_f32_bf16 v33, v64, v14, 0
    v_dot2_f32_bf16 v34, v68, v14, 0
    v_dot2_f32_bf16 v35, v72, v14, 0
    v_dot2_f32_bf16 v36, v76, v14, 0
    v_dot2c_f32_bf16 v33, v65, v15
    v_dot2c_f32_bf16 v34, v69, v15
    v_dot2c_f32_bf16 v35, v73, v15
    v_dot2c_f32_bf16 v36, v77, v15
    v_dot2c_f32_bf16 v33, v66, v16
    v_dot2c_f32_bf16 v34, v70, v16
    v_dot2c_f32_bf16 v35, v74, v16
    v_dot2c_f32_bf16 v36, v78, v16
    v_dot2c_f32_bf16 v33, v67, v17
    v_dot2c_f32_bf16 v34, v71, v17
    v_dot2c_f32_bf16 v35, v75, v17
    v_dot2c_f32_bf16 v36, v79, v17
    s_waitcnt vmcnt(7)
    buffer_load_dwordx4 v[64:67], v8, s[32:35], s65 offen offset:0 nt
    s_waitcnt vmcnt(7)
    buffer_load_dwordx4 v[68:71], v8, s[32:35], s65 offen offset:1024 nt
    s_waitcnt vmcnt(7)
    buffer_load_dwordx4 v[72:75], v8, s[32:35], s65 offen offset:2048 nt
    s_waitcnt vmcnt(7)
    buffer_load_dwordx4 v[76:79], v8, s[32:35], s65 offen offset:3072 nt
    v_add_f32_dpp v37, v33, v33 row_ror:8 row_mask:0xf bank_mask:0x3
    v_add_f32_dpp v38, v34, v34 row_ror:8 row_mask:0xf bank_mask:0x3
    v_add_f32_dpp v37, v35, v35 row_ror:8 row_mask:0xf bank_mask:0xc
    v_add_f32_dpp v38, v36, v36 row_ror:8 row_mask:0xf bank_mask:0xc
    s_nop 1
    v_add_f32_dpp v46, v37, v37 row_half_mirror row_mask:0xf bank_mask:0x5
    v_add_f32_dpp v46, v38, v38 row_half_mirror row_mask:0xf bank_mask:0xa
    s_nop 1
    v_add_f32_dpp v46, v46, v46 quad_perm:[1,0,3,2] row_mask:0xf bank_mask:0xf
    s_nop 1
    v_add_f32_dpp v46, v46, v46 quad_perm:[2,3,0,1] row_mask:0xf bank_mask:0xf
    v_cvt_pk_bf16_f32 v46, v46, v46
    v_lshlrev_b32 v46, 16, v46
    v_mul_f32 v46, 0x3db504f3, v46
    v_cvt_pk_bf16_f32 v46, v46, v46
    v_lshlrev_b32 v46, 16, v46
    s_waitcnt vmcnt(4)
    s_mov_b32 s24, 0
recurrent_scan__gqa_block_cached__dense_activation_silu__decode_kernel_hchk:
    v_xor_b32 v32, s73, v185
    v_xor_b32 v33, s74, v187
    v_or_b32 v32, v32, v33
    v_cmp_ne_u32 vcc, 0, v32
    s_add_u32 s24, s24, 1
    s_cbranch_vccz recurrent_scan__gqa_block_cached__dense_activation_silu__decode_kernel_hok
    s_cmp_eq_u32 s25, 0
    s_cbranch_scc1 recurrent_scan__gqa_block_cached__dense_activation_silu__decode_kernel_hok
    s_cmp_ge_u32 s24, 0x40000
    s_cbranch_scc1 recurrent_scan__gqa_block_cached__dense_activation_silu__decode_kernel_hok
    buffer_load_dwordx4 v[184:187], v190, s[48:51], 0 offen sc0 sc1
    s_waitcnt vmcnt(0)
    s_branch recurrent_scan__gqa_block_cached__dense_activation_silu__decode_kernel_hchk
recurrent_scan__gqa_block_cached__dense_activation_silu__decode_kernel_hok:
    s_nop 0
    v_add_f32_dpp v184, v184, v184 row_ror:4 row_mask:0xf bank_mask:0xf
    v_add_f32_dpp v186, v186, v186 row_ror:4 row_mask:0xf bank_mask:0xf
    s_nop 0
    v_add_f32_dpp v184, v184, v184 row_ror:8 row_mask:0xf bank_mask:0xf
    v_add_f32_dpp v186, v186, v186 row_ror:8 row_mask:0xf bank_mask:0xf
    v_mov_b32 v32, v184
    v_mov_b32 v33, v186
    s_nop 0
    v_permlane16_swap_b32 v184, v32
    v_permlane16_swap_b32 v186, v33
    s_nop 0
    v_add_f32 v184, v184, v32
    v_add_f32 v186, v186, v33
    s_and_b32 s26, s3, 1
    s_cmp_eq_u32 s26, 1
    s_cselect_b64 s[26:27], -1, 0
    s_lshr_b32 s24, s3, 1
    s_add_u32 s68, s24, 2
    v_cndmask_b32 v184, v184, v186, s[26:27]
    s_nop 0
    v_readlane_b32 s26, v184, s24
    v_readlane_b32 s27, v184, s68
    s_nop 1
    v_mov_b32 v32, s26
    v_mov_b32 v39, s27
    v_cvt_pk_bf16_f32 v32, v32, v32
    v_lshlrev_b32 v32, 16, v32
    v_cvt_pk_bf16_f32 v39, v39, v39
    v_lshlrev_b32 v39, 16, v39
    v_mul_f32 v33, 0xbfb8aa3b, v32
    v_exp_f32 v33, v33
    s_nop 0
    v_add_f32 v33, 1.0, v33
    v_rcp_f32 v34, v33
    s_nop 0
    v_mul_f32 v35, v32, v34
    v_fma_f32 v36, -v35, v33, v32
    v_fma_f32 v35, v36, v34, v35
    v_cmp_lt_f32 vcc, 0x7f000000, v33
    v_mul_f32 v36, v32, v34
    s_nop 0
    v_cndmask_b32 v32, v35, v36, vcc
    v_cvt_pk_bf16_f32 v32, v32, v32
    v_lshlrev_b32 v32, 16, v32
    v_mul_f32 v33, 0xbfb8aa3b, v39
    v_exp_f32 v33, v33
    s_nop 0
    v_add_f32 v33, 1.0, v33
    v_rcp_f32 v34, v33
    s_nop 0
    v_mul_f32 v35, v39, v34
    v_fma_f32 v36, -v35, v33, v39
    v_fma_f32 v35, v36, v34, v35
    v_cmp_lt_f32 vcc, 0x7f000000, v33
    v_mul_f32 v36, v39, v34
    s_nop 0
    v_cndmask_b32 v39, v35, v36, vcc
    v_cvt_pk_bf16_f32 v39, v39, v39
    v_lshlrev_b32 v39, 16, v39
    v_lshlrev_b32 v192, 16, v168
    v_and_b32 v193, 0xffff0000, v168
    v_lshlrev_b32 v40, 16, v172
    v_and_b32 v41, 0xffff0000, v172
    v_mul_f32 v192, v192, v32
    v_mul_f32 v193, v193, v32
    v_fmac_f32 v192, v40, v39
    v_fmac_f32 v193, v41, v39
    v_lshlrev_b32 v194, 16, v169
    v_and_b32 v195, 0xffff0000, v169
    v_lshlrev_b32 v40, 16, v173
    v_and_b32 v41, 0xffff0000, v173
    v_mul_f32 v194, v194, v32
    v_mul_f32 v195, v195, v32
    v_fmac_f32 v194, v40, v39
    v_fmac_f32 v195, v41, v39
    v_lshlrev_b32 v196, 16, v170
    v_and_b32 v197, 0xffff0000, v170
    v_lshlrev_b32 v40, 16, v174
    v_and_b32 v41, 0xffff0000, v174
    v_mul_f32 v196, v196, v32
    v_mul_f32 v197, v197, v32
    v_fmac_f32 v196, v40, v39
    v_fmac_f32 v197, v41, v39
    v_lshlrev_b32 v198, 16, v171
    v_and_b32 v199, 0xffff0000, v171
    v_lshlrev_b32 v40, 16, v175
    v_and_b32 v41, 0xffff0000, v175
    v_mul_f32 v198, v198, v32
    v_mul_f32 v199, v199, v32
    v_fmac_f32 v198, v40, v39
    v_fmac_f32 v199, v41, v39
    v_lshlrev_b32 v33, 5, v1
    s_lshl_b32 s26, s3, 11
    v_add_u32 v33, s26, v33
    ds_write_b128 v33, v[192:195] offset:8192
    ds_write_b128 v33, v[196:199] offset:8208
    s_waitcnt lgkmcnt(0)
    v_dot2_f32_bf16 v33, v80, v14, 0
    v_dot2_f32_bf16 v34, v84, v14, 0
    v_dot2_f32_bf16 v35, v88, v14, 0
    v_dot2_f32_bf16 v36, v92, v14, 0
    v_dot2c_f32_bf16 v33, v81, v15
    v_dot2c_f32_bf16 v34, v85, v15
    v_dot2c_f32_bf16 v35, v89, v15
    v_dot2c_f32_bf16 v36, v93, v15
    v_dot2c_f32_bf16 v33, v82, v16
    v_dot2c_f32_bf16 v34, v86, v16
    v_dot2c_f32_bf16 v35, v90, v16
    v_dot2c_f32_bf16 v36, v94, v16
    v_dot2c_f32_bf16 v33, v83, v17
    v_dot2c_f32_bf16 v34, v87, v17
    v_dot2c_f32_bf16 v35, v91, v17
    v_dot2c_f32_bf16 v36, v95, v17
    buffer_load_dwordx4 v[80:83], v9, s[32:35], s65 offen offset:0 nt
    buffer_load_dwordx4 v[84:87], v9, s[32:35], s65 offen offset:1024 nt
    buffer_load_dwordx4 v[88:91], v9, s[32:35], s65 offen offset:2048 nt
    buffer_load_dwordx4 v[92:95], v9, s[32:35], s65 offen offset:3072 nt
    v_add_f32_dpp v37, v33, v33 row_ror:8 row_mask:0xf bank_mask:0x3
    v_add_f32_dpp v38, v34, v34 row_ror:8 row_mask:0xf bank_mask:0x3
    v_add_f32_dpp v37, v35, v35 row_ror:8 row_mask:0xf bank_mask:0xc
    v_add_f32_dpp v38, v36, v36 row_ror:8 row_mask:0xf bank_mask:0xc
    s_nop 1
    v_add_f32_dpp v47, v37, v37 row_half_mirror row_mask:0xf bank_mask:0x5
    v_add_f32_dpp v47, v38, v38 row_half_mirror row_mask:0xf bank_mask:0xa
    s_nop 1
    v_add_f32_dpp v47, v47, v47 quad_perm:[1,0,3,2] row_mask:0xf bank_mask:0xf
    s_nop 1
    v_add_f32_dpp v47, v47, v47 quad_perm:[2,3,0,1] row_mask:0xf bank_mask:0xf
    v_cvt_pk_bf16_f32 v47, v47, v47
    v_lshlrev_b32 v47, 16, v47
    v_mul_f32 v47, 0x3db504f3, v47
    v_cvt_pk_bf16_f32 v47, v47, v47
    v_lshlrev_b32 v47, 16, v47
    s_barrier
    v_lshlrev_b32 v32, 3, v0
    ds_read_b64 v[38:39], v32 offset:8192
    ds_read_b64 v[40:41], v32 offset:10240
    ds_read_b64 v[42:43], v32 offset:12288
    ds_read_b64 v[44:45], v32 offset:14336
    s_lshl_b32 s26, s23, 12
    s_add_u32 s26, s26, 1081344
    s_lshl_b32 s27, s25, 12
    s_add_u32 s60, s14, s26
    s_addc_u32 s61, s15, 0
    s_mov_b32 s62, s27
    s_mov_b32 s63, 0x00020000
    v_lshlrev_b32 v33, 4, v0
    s_waitcnt lgkmcnt(0)
    v_add_f32 v38, v38, v40
    v_add_f32 v39, v39, v41
    v_add_f32 v42, v42, v44
    v_add_f32 v43, v43, v45
    v_add_f32 v38, v38, v42
    v_add_f32 v40, v39, v43
    v_mov_b32 v39, s73
    v_mov_b32 v41, s74
    buffer_store_dwordx4 v[38:41], v33, s[60:63], 0 offen sc0 sc1
    v_dot2_f32_bf16 v33, v96, v14, 0
    v_dot2_f32_bf16 v34, v100, v14, 0
    v_dot2_f32_bf16 v35, v104, v14, 0
    v_dot2_f32_bf16 v36, v108, v14, 0
    v_dot2c_f32_bf16 v33, v97, v15
    v_dot2c_f32_bf16 v34, v101, v15
    v_dot2c_f32_bf16 v35, v105, v15
    v_dot2c_f32_bf16 v36, v109, v15
    v_dot2c_f32_bf16 v33, v98, v16
    v_dot2c_f32_bf16 v34, v102, v16
    v_dot2c_f32_bf16 v35, v106, v16
    v_dot2c_f32_bf16 v36, v110, v16
    v_dot2c_f32_bf16 v33, v99, v17
    v_dot2c_f32_bf16 v34, v103, v17
    v_dot2c_f32_bf16 v35, v107, v17
    v_dot2c_f32_bf16 v36, v111, v17
    s_waitcnt vmcnt(7)
    buffer_load_dwordx4 v[96:99], v10, s[32:35], s65 offen offset:0 nt
    s_waitcnt vmcnt(7)
    buffer_load_dwordx4 v[100:103], v10, s[32:35], s65 offen offset:1024 nt
    s_waitcnt vmcnt(7)
    buffer_load_dwordx4 v[104:107], v10, s[32:35], s65 offen offset:2048 nt
    s_waitcnt vmcnt(7)
    buffer_load_dwordx4 v[108:111], v10, s[32:35], s65 offen offset:3072 nt
    v_add_f32_dpp v37, v33, v33 row_ror:8 row_mask:0xf bank_mask:0x3
    v_add_f32_dpp v38, v34, v34 row_ror:8 row_mask:0xf bank_mask:0x3
    v_add_f32_dpp v37, v35, v35 row_ror:8 row_mask:0xf bank_mask:0xc
    v_add_f32_dpp v38, v36, v36 row_ror:8 row_mask:0xf bank_mask:0xc
    s_nop 1
    v_add_f32_dpp v48, v37, v37 row_half_mirror row_mask:0xf bank_mask:0x5
    v_add_f32_dpp v48, v38, v38 row_half_mirror row_mask:0xf bank_mask:0xa
    s_nop 1
    v_add_f32_dpp v48, v48, v48 quad_perm:[1,0,3,2] row_mask:0xf bank_mask:0xf
    s_nop 1
    v_add_f32_dpp v48, v48, v48 quad_perm:[2,3,0,1] row_mask:0xf bank_mask:0xf
    v_cvt_pk_bf16_f32 v48, v48, v48
    v_lshlrev_b32 v48, 16, v48
    v_mul_f32 v48, 0x3db504f3, v48
    v_cvt_pk_bf16_f32 v48, v48, v48
    v_lshlrev_b32 v48, 16, v48
    v_dot2_f32_bf16 v33, v112, v14, 0
    v_dot2_f32_bf16 v34, v116, v14, 0
    v_dot2_f32_bf16 v35, v120, v14, 0
    v_dot2_f32_bf16 v36, v124, v14, 0
    v_dot2c_f32_bf16 v33, v113, v15
    v_dot2c_f32_bf16 v34, v117, v15
    v_dot2c_f32_bf16 v35, v121, v15
    v_dot2c_f32_bf16 v36, v125, v15
    v_dot2c_f32_bf16 v33, v114, v16
    v_dot2c_f32_bf16 v34, v118, v16
    v_dot2c_f32_bf16 v35, v122, v16
    v_dot2c_f32_bf16 v36, v126, v16
    v_dot2c_f32_bf16 v33, v115, v17
    v_dot2c_f32_bf16 v34, v119, v17
    v_dot2c_f32_bf16 v35, v123, v17
    v_dot2c_f32_bf16 v36, v127, v17
    s_waitcnt vmcnt(7)
    buffer_load_dwordx4 v[112:115], v11, s[32:35], s65 offen offset:0 nt
    s_waitcnt vmcnt(7)
    buffer_load_dwordx4 v[116:119], v11, s[32:35], s65 offen offset:1024 nt
    s_waitcnt vmcnt(7)
    buffer_load_dwordx4 v[120:123], v11, s[32:35], s65 offen offset:2048 nt
    s_waitcnt vmcnt(7)
    buffer_load_dwordx4 v[124:127], v11, s[32:35], s65 offen offset:3072 nt
    v_add_f32_dpp v37, v33, v33 row_ror:8 row_mask:0xf bank_mask:0x3
    v_add_f32_dpp v38, v34, v34 row_ror:8 row_mask:0xf bank_mask:0x3
    v_add_f32_dpp v37, v35, v35 row_ror:8 row_mask:0xf bank_mask:0xc
    v_add_f32_dpp v38, v36, v36 row_ror:8 row_mask:0xf bank_mask:0xc
    s_nop 1
    v_add_f32_dpp v49, v37, v37 row_half_mirror row_mask:0xf bank_mask:0x5
    v_add_f32_dpp v49, v38, v38 row_half_mirror row_mask:0xf bank_mask:0xa
    s_nop 1
    v_add_f32_dpp v49, v49, v49 quad_perm:[1,0,3,2] row_mask:0xf bank_mask:0xf
    s_nop 1
    v_add_f32_dpp v49, v49, v49 quad_perm:[2,3,0,1] row_mask:0xf bank_mask:0xf
    v_cvt_pk_bf16_f32 v49, v49, v49
    v_lshlrev_b32 v49, 16, v49
    v_mul_f32 v49, 0x3db504f3, v49
    v_cvt_pk_bf16_f32 v49, v49, v49
    v_lshlrev_b32 v49, 16, v49
    v_dot2_f32_bf16 v33, v64, v14, 0
    v_dot2_f32_bf16 v34, v68, v14, 0
    v_dot2_f32_bf16 v35, v72, v14, 0
    v_dot2_f32_bf16 v36, v76, v14, 0
    v_dot2c_f32_bf16 v33, v65, v15
    v_dot2c_f32_bf16 v34, v69, v15
    v_dot2c_f32_bf16 v35, v73, v15
    v_dot2c_f32_bf16 v36, v77, v15
    v_dot2c_f32_bf16 v33, v66, v16
    v_dot2c_f32_bf16 v34, v70, v16
    v_dot2c_f32_bf16 v35, v74, v16
    v_dot2c_f32_bf16 v36, v78, v16
    v_dot2c_f32_bf16 v33, v67, v17
    v_dot2c_f32_bf16 v34, v71, v17
    v_dot2c_f32_bf16 v35, v75, v17
    v_dot2c_f32_bf16 v36, v79, v17
    s_waitcnt vmcnt(7)
    buffer_load_dwordx4 v[64:67], v8, s[32:35], s66 offen offset:0 nt
    s_waitcnt vmcnt(7)
    buffer_load_dwordx4 v[68:71], v8, s[32:35], s66 offen offset:1024 nt
    s_waitcnt vmcnt(7)
    buffer_load_dwordx4 v[72:75], v8, s[32:35], s66 offen offset:2048 nt
    s_waitcnt vmcnt(7)
    buffer_load_dwordx4 v[76:79], v8, s[32:35], s66 offen offset:3072 nt
    s_waitcnt vmcnt(7)
    s_mov_b32 s69, 0
    buffer_load_dwordx4 v[128:131], v63, s[44:47], s69 offen offset:0
    s_waitcnt vmcnt(7)
    s_mov_b32 s69, 0
    buffer_load_dwordx4 v[132:135], v63, s[44:47], s69 offen offset:1024
    s_waitcnt vmcnt(7)
    s_mov_b32 s69, 0
    buffer_load_dwordx4 v[136:139], v63, s[44:47], s69 offen offset:2048
    s_waitcnt vmcnt(7)
    s_mov_b32 s69, 0
    buffer_load_dwordx4 v[140:143], v63, s[44:47], s69 offen offset:3072
    v_add_f32_dpp v37, v33, v33 row_ror:8 row_mask:0xf bank_mask:0x3
    v_add_f32_dpp v38, v34, v34 row_ror:8 row_mask:0xf bank_mask:0x3
    v_add_f32_dpp v37, v35, v35 row_ror:8 row_mask:0xf bank_mask:0xc
    v_add_f32_dpp v38, v36, v36 row_ror:8 row_mask:0xf bank_mask:0xc
    s_nop 1
    v_add_f32_dpp v50, v37, v37 row_half_mirror row_mask:0xf bank_mask:0x5
    v_add_f32_dpp v50, v38, v38 row_half_mirror row_mask:0xf bank_mask:0xa
    s_nop 1
    v_add_f32_dpp v50, v50, v50 quad_perm:[1,0,3,2] row_mask:0xf bank_mask:0xf
    s_nop 1
    v_add_f32_dpp v50, v50, v50 quad_perm:[2,3,0,1] row_mask:0xf bank_mask:0xf
    v_cvt_pk_bf16_f32 v50, v50, v50
    v_lshlrev_b32 v50, 16, v50
    v_mul_f32 v50, 0x3db504f3, v50
    v_cvt_pk_bf16_f32 v50, v50, v50
    v_lshlrev_b32 v50, 16, v50
    v_dot2_f32_bf16 v33, v80, v14, 0
    v_dot2_f32_bf16 v34, v84, v14, 0
    v_dot2_f32_bf16 v35, v88, v14, 0
    v_dot2_f32_bf16 v36, v92, v14, 0
    v_dot2c_f32_bf16 v33, v81, v15
    v_dot2c_f32_bf16 v34, v85, v15
    v_dot2c_f32_bf16 v35, v89, v15
    v_dot2c_f32_bf16 v36, v93, v15
    v_dot2c_f32_bf16 v33, v82, v16
    v_dot2c_f32_bf16 v34, v86, v16
    v_dot2c_f32_bf16 v35, v90, v16
    v_dot2c_f32_bf16 v36, v94, v16
    v_dot2c_f32_bf16 v33, v83, v17
    v_dot2c_f32_bf16 v34, v87, v17
    v_dot2c_f32_bf16 v35, v91, v17
    v_dot2c_f32_bf16 v36, v95, v17
    s_waitcnt vmcnt(7)
    buffer_load_dwordx4 v[80:83], v9, s[32:35], s66 offen offset:0 nt
    s_waitcnt vmcnt(7)
    buffer_load_dwordx4 v[84:87], v9, s[32:35], s66 offen offset:1024 nt
    s_waitcnt vmcnt(7)
    buffer_load_dwordx4 v[88:91], v9, s[32:35], s66 offen offset:2048 nt
    s_waitcnt vmcnt(7)
    buffer_load_dwordx4 v[92:95], v9, s[32:35], s66 offen offset:3072 nt
    s_waitcnt vmcnt(7)
    s_mov_b32 s69, 4096
    buffer_load_dwordx4 v[144:147], v63, s[44:47], s69 offen offset:0
    s_waitcnt vmcnt(7)
    s_mov_b32 s69, 4096
    buffer_load_dwordx4 v[148:151], v63, s[44:47], s69 offen offset:1024
    s_waitcnt vmcnt(7)
    s_mov_b32 s69, 4096
    buffer_load_dwordx4 v[152:155], v63, s[44:47], s69 offen offset:2048
    s_waitcnt vmcnt(7)
    s_mov_b32 s69, 4096
    buffer_load_dwordx4 v[156:159], v63, s[44:47], s69 offen offset:3072
    v_add_f32_dpp v37, v33, v33 row_ror:8 row_mask:0xf bank_mask:0x3
    v_add_f32_dpp v38, v34, v34 row_ror:8 row_mask:0xf bank_mask:0x3
    v_add_f32_dpp v37, v35, v35 row_ror:8 row_mask:0xf bank_mask:0xc
    v_add_f32_dpp v38, v36, v36 row_ror:8 row_mask:0xf bank_mask:0xc
    s_nop 1
    v_add_f32_dpp v51, v37, v37 row_half_mirror row_mask:0xf bank_mask:0x5
    v_add_f32_dpp v51, v38, v38 row_half_mirror row_mask:0xf bank_mask:0xa
    s_nop 1
    v_add_f32_dpp v51, v51, v51 quad_perm:[1,0,3,2] row_mask:0xf bank_mask:0xf
    s_nop 1
    v_add_f32_dpp v51, v51, v51 quad_perm:[2,3,0,1] row_mask:0xf bank_mask:0xf
    v_cvt_pk_bf16_f32 v51, v51, v51
    v_lshlrev_b32 v51, 16, v51
    v_mul_f32 v51, 0x3db504f3, v51
    v_cvt_pk_bf16_f32 v51, v51, v51
    v_lshlrev_b32 v51, 16, v51
    v_dot2_f32_bf16 v33, v96, v14, 0
    v_dot2_f32_bf16 v34, v100, v14, 0
    v_dot2_f32_bf16 v35, v104, v14, 0
    v_dot2_f32_bf16 v36, v108, v14, 0
    v_dot2c_f32_bf16 v33, v97, v15
    v_dot2c_f32_bf16 v34, v101, v15
    v_dot2c_f32_bf16 v35, v105, v15
    v_dot2c_f32_bf16 v36, v109, v15
    v_dot2c_f32_bf16 v33, v98, v16
    v_dot2c_f32_bf16 v34, v102, v16
    v_dot2c_f32_bf16 v35, v106, v16
    v_dot2c_f32_bf16 v36, v110, v16
    v_dot2c_f32_bf16 v33, v99, v17
    v_dot2c_f32_bf16 v34, v103, v17
    v_dot2c_f32_bf16 v35, v107, v17
    v_dot2c_f32_bf16 v36, v111, v17
    s_waitcnt vmcnt(7)
    buffer_load_dwordx4 v[96:99], v10, s[32:35], s66 offen offset:0 nt
    s_waitcnt vmcnt(7)
    buffer_load_dwordx4 v[100:103], v10, s[32:35], s66 offen offset:1024 nt
    s_waitcnt vmcnt(7)
    buffer_load_dwordx4 v[104:107], v10, s[32:35], s66 offen offset:2048 nt
    s_waitcnt vmcnt(7)
    buffer_load_dwordx4 v[108:111], v10, s[32:35], s66 offen offset:3072 nt
    s_waitcnt vmcnt(7)
    s_mov_b32 s69, 8192
    buffer_load_dwordx4 v[160:163], v63, s[44:47], s69 offen offset:0
    s_waitcnt vmcnt(7)
    s_mov_b32 s69, 8192
    buffer_load_dwordx4 v[164:167], v63, s[44:47], s69 offen offset:1024
    s_waitcnt vmcnt(7)
    s_mov_b32 s69, 8192
    buffer_load_dwordx4 v[168:171], v63, s[44:47], s69 offen offset:2048
    s_waitcnt vmcnt(7)
    s_mov_b32 s69, 8192
    buffer_load_dwordx4 v[172:175], v63, s[44:47], s69 offen offset:3072
    v_add_f32_dpp v37, v33, v33 row_ror:8 row_mask:0xf bank_mask:0x3
    v_add_f32_dpp v38, v34, v34 row_ror:8 row_mask:0xf bank_mask:0x3
    v_add_f32_dpp v37, v35, v35 row_ror:8 row_mask:0xf bank_mask:0xc
    v_add_f32_dpp v38, v36, v36 row_ror:8 row_mask:0xf bank_mask:0xc
    s_nop 1
    v_add_f32_dpp v52, v37, v37 row_half_mirror row_mask:0xf bank_mask:0x5
    v_add_f32_dpp v52, v38, v38 row_half_mirror row_mask:0xf bank_mask:0xa
    s_nop 1
    v_add_f32_dpp v52, v52, v52 quad_perm:[1,0,3,2] row_mask:0xf bank_mask:0xf
    s_nop 1
    v_add_f32_dpp v52, v52, v52 quad_perm:[2,3,0,1] row_mask:0xf bank_mask:0xf
    v_cvt_pk_bf16_f32 v52, v52, v52
    v_lshlrev_b32 v52, 16, v52
    v_mul_f32 v52, 0x3db504f3, v52
    v_cvt_pk_bf16_f32 v52, v52, v52
    v_lshlrev_b32 v52, 16, v52
    v_dot2_f32_bf16 v33, v112, v14, 0
    v_dot2_f32_bf16 v34, v116, v14, 0
    v_dot2_f32_bf16 v35, v120, v14, 0
    v_dot2_f32_bf16 v36, v124, v14, 0
    v_dot2c_f32_bf16 v33, v113, v15
    v_dot2c_f32_bf16 v34, v117, v15
    v_dot2c_f32_bf16 v35, v121, v15
    v_dot2c_f32_bf16 v36, v125, v15
    v_dot2c_f32_bf16 v33, v114, v16
    v_dot2c_f32_bf16 v34, v118, v16
    v_dot2c_f32_bf16 v35, v122, v16
    v_dot2c_f32_bf16 v36, v126, v16
    v_dot2c_f32_bf16 v33, v115, v17
    v_dot2c_f32_bf16 v34, v119, v17
    v_dot2c_f32_bf16 v35, v123, v17
    v_dot2c_f32_bf16 v36, v127, v17
    s_waitcnt vmcnt(7)
    buffer_load_dwordx4 v[112:115], v11, s[32:35], s66 offen offset:0 nt
    s_waitcnt vmcnt(7)
    buffer_load_dwordx4 v[116:119], v11, s[32:35], s66 offen offset:1024 nt
    s_waitcnt vmcnt(7)
    buffer_load_dwordx4 v[120:123], v11, s[32:35], s66 offen offset:2048 nt
    s_waitcnt vmcnt(7)
    buffer_load_dwordx4 v[124:127], v11, s[32:35], s66 offen offset:3072 nt
    s_waitcnt vmcnt(7)
    s_mov_b32 s69, 12288
    buffer_load_dwordx4 v[176:179], v63, s[44:47], s69 offen offset:0
    s_waitcnt vmcnt(7)
    s_mov_b32 s69, 12288
    buffer_load_dwordx4 v[180:183], v63, s[44:47], s69 offen offset:1024
    s_waitcnt vmcnt(7)
    s_mov_b32 s69, 12288
    buffer_load_dwordx4 v[184:187], v63, s[44:47], s69 offen offset:2048
    s_waitcnt vmcnt(7)
    s_mov_b32 s69, 12288
    buffer_load_dwordx4 v[188:191], v63, s[44:47], s69 offen offset:3072
    v_add_f32_dpp v37, v33, v33 row_ror:8 row_mask:0xf bank_mask:0x3
    v_add_f32_dpp v38, v34, v34 row_ror:8 row_mask:0xf bank_mask:0x3
    v_add_f32_dpp v37, v35, v35 row_ror:8 row_mask:0xf bank_mask:0xc
    v_add_f32_dpp v38, v36, v36 row_ror:8 row_mask:0xf bank_mask:0xc
    s_nop 1
    v_add_f32_dpp v53, v37, v37 row_half_mirror row_mask:0xf bank_mask:0x5
    v_add_f32_dpp v53, v38, v38 row_half_mirror row_mask:0xf bank_mask:0xa
    s_nop 1
    v_add_f32_dpp v53, v53, v53 quad_perm:[1,0,3,2] row_mask:0xf bank_mask:0xf
    s_nop 1
    v_add_f32_dpp v53, v53, v53 quad_perm:[2,3,0,1] row_mask:0xf bank_mask:0xf
    v_cvt_pk_bf16_f32 v53, v53, v53
    v_lshlrev_b32 v53, 16, v53
    v_mul_f32 v53, 0x3db504f3, v53
    v_cvt_pk_bf16_f32 v53, v53, v53
    v_lshlrev_b32 v53, 16, v53
    v_dot2_f32_bf16 v33, v64, v14, 0
    v_dot2_f32_bf16 v34, v68, v14, 0
    v_dot2_f32_bf16 v35, v72, v14, 0
    v_dot2_f32_bf16 v36, v76, v14, 0
    v_dot2c_f32_bf16 v33, v65, v15
    v_dot2c_f32_bf16 v34, v69, v15
    v_dot2c_f32_bf16 v35, v73, v15
    v_dot2c_f32_bf16 v36, v77, v15
    v_dot2c_f32_bf16 v33, v66, v16
    v_dot2c_f32_bf16 v34, v70, v16
    v_dot2c_f32_bf16 v35, v74, v16
    v_dot2c_f32_bf16 v36, v78, v16
    v_dot2c_f32_bf16 v33, v67, v17
    v_dot2c_f32_bf16 v34, v71, v17
    v_dot2c_f32_bf16 v35, v75, v17
    v_dot2c_f32_bf16 v36, v79, v17
    s_waitcnt vmcnt(7)
    buffer_load_dwordx4 v[64:67], v8, s[32:35], s67 offen offset:0 nt
    s_waitcnt vmcnt(7)
    buffer_load_dwordx4 v[68:71], v8, s[32:35], s67 offen offset:1024 nt
    s_waitcnt vmcnt(7)
    buffer_load_dwordx4 v[72:75], v8, s[32:35], s67 offen offset:2048 nt
    s_waitcnt vmcnt(7)
    buffer_load_dwordx4 v[76:79], v8, s[32:35], s67 offen offset:3072 nt
    s_waitcnt vmcnt(7)
    s_mov_b32 s69, 16384
    buffer_load_dwordx4 v[192:195], v63, s[44:47], s69 offen offset:0
    s_waitcnt vmcnt(7)
    s_mov_b32 s69, 16384
    buffer_load_dwordx4 v[196:199], v63, s[44:47], s69 offen offset:1024
    s_waitcnt vmcnt(7)
    s_mov_b32 s69, 16384
    buffer_load_dwordx4 v[200:203], v63, s[44:47], s69 offen offset:2048
    s_waitcnt vmcnt(7)
    s_mov_b32 s69, 16384
    buffer_load_dwordx4 v[204:207], v63, s[44:47], s69 offen offset:3072
    v_add_f32_dpp v37, v33, v33 row_ror:8 row_mask:0xf bank_mask:0x3
    v_add_f32_dpp v38, v34, v34 row_ror:8 row_mask:0xf bank_mask:0x3
    v_add_f32_dpp v37, v35, v35 row_ror:8 row_mask:0xf bank_mask:0xc
    v_add_f32_dpp v38, v36, v36 row_ror:8 row_mask:0xf bank_mask:0xc
    s_nop 1
    v_add_f32_dpp v54, v37, v37 row_half_mirror row_mask:0xf bank_mask:0x5
    v_add_f32_dpp v54, v38, v38 row_half_mirror row_mask:0xf bank_mask:0xa
    s_nop 1
    v_add_f32_dpp v54, v54, v54 quad_perm:[1,0,3,2] row_mask:0xf bank_mask:0xf
    s_nop 1
    v_add_f32_dpp v54, v54, v54 quad_perm:[2,3,0,1] row_mask:0xf bank_mask:0xf
    v_cvt_pk_bf16_f32 v54, v54, v54
    v_lshlrev_b32 v54, 16, v54
    v_mul_f32 v54, 0x3db504f3, v54
    v_cvt_pk_bf16_f32 v54, v54, v54
    v_lshlrev_b32 v54, 16, v54
    v_dot2_f32_bf16 v33, v80, v14, 0
    v_dot2_f32_bf16 v34, v84, v14, 0
    v_dot2_f32_bf16 v35, v88, v14, 0
    v_dot2_f32_bf16 v36, v92, v14, 0
    v_dot2c_f32_bf16 v33, v81, v15
    v_dot2c_f32_bf16 v34, v85, v15
    v_dot2c_f32_bf16 v35, v89, v15
    v_dot2c_f32_bf16 v36, v93, v15
    v_dot2c_f32_bf16 v33, v82, v16
    v_dot2c_f32_bf16 v34, v86, v16
    v_dot2c_f32_bf16 v35, v90, v16
    v_dot2c_f32_bf16 v36, v94, v16
    v_dot2c_f32_bf16 v33, v83, v17
    v_dot2c_f32_bf16 v34, v87, v17
    v_dot2c_f32_bf16 v35, v91, v17
    v_dot2c_f32_bf16 v36, v95, v17
    s_waitcnt vmcnt(7)
    buffer_load_dwordx4 v[80:83], v9, s[32:35], s67 offen offset:0 nt
    s_waitcnt vmcnt(7)
    buffer_load_dwordx4 v[84:87], v9, s[32:35], s67 offen offset:1024 nt
    s_waitcnt vmcnt(7)
    buffer_load_dwordx4 v[88:91], v9, s[32:35], s67 offen offset:2048 nt
    s_waitcnt vmcnt(7)
    buffer_load_dwordx4 v[92:95], v9, s[32:35], s67 offen offset:3072 nt
    s_waitcnt vmcnt(7)
    s_mov_b32 s69, 20480
    buffer_load_dwordx4 v[208:211], v63, s[44:47], s69 offen offset:0
    s_waitcnt vmcnt(7)
    s_mov_b32 s69, 20480
    buffer_load_dwordx4 v[212:215], v63, s[44:47], s69 offen offset:1024
    s_waitcnt vmcnt(7)
    s_mov_b32 s69, 20480
    buffer_load_dwordx4 v[216:219], v63, s[44:47], s69 offen offset:2048
    s_waitcnt vmcnt(7)
    s_mov_b32 s69, 20480
    buffer_load_dwordx4 v[220:223], v63, s[44:47], s69 offen offset:3072
    v_add_f32_dpp v37, v33, v33 row_ror:8 row_mask:0xf bank_mask:0x3
    v_add_f32_dpp v38, v34, v34 row_ror:8 row_mask:0xf bank_mask:0x3
    v_add_f32_dpp v37, v35, v35 row_ror:8 row_mask:0xf bank_mask:0xc
    v_add_f32_dpp v38, v36, v36 row_ror:8 row_mask:0xf bank_mask:0xc
    s_nop 1
    v_add_f32_dpp v55, v37, v37 row_half_mirror row_mask:0xf bank_mask:0x5
    v_add_f32_dpp v55, v38, v38 row_half_mirror row_mask:0xf bank_mask:0xa
    s_nop 1
    v_add_f32_dpp v55, v55, v55 quad_perm:[1,0,3,2] row_mask:0xf bank_mask:0xf
    s_nop 1
    v_add_f32_dpp v55, v55, v55 quad_perm:[2,3,0,1] row_mask:0xf bank_mask:0xf
    v_cvt_pk_bf16_f32 v55, v55, v55
    v_lshlrev_b32 v55, 16, v55
    v_mul_f32 v55, 0x3db504f3, v55
    v_cvt_pk_bf16_f32 v55, v55, v55
    v_lshlrev_b32 v55, 16, v55
    v_dot2_f32_bf16 v33, v96, v14, 0
    v_dot2_f32_bf16 v34, v100, v14, 0
    v_dot2_f32_bf16 v35, v104, v14, 0
    v_dot2_f32_bf16 v36, v108, v14, 0
    v_dot2c_f32_bf16 v33, v97, v15
    v_dot2c_f32_bf16 v34, v101, v15
    v_dot2c_f32_bf16 v35, v105, v15
    v_dot2c_f32_bf16 v36, v109, v15
    v_dot2c_f32_bf16 v33, v98, v16
    v_dot2c_f32_bf16 v34, v102, v16
    v_dot2c_f32_bf16 v35, v106, v16
    v_dot2c_f32_bf16 v36, v110, v16
    v_dot2c_f32_bf16 v33, v99, v17
    v_dot2c_f32_bf16 v34, v103, v17
    v_dot2c_f32_bf16 v35, v107, v17
    v_dot2c_f32_bf16 v36, v111, v17
    s_waitcnt vmcnt(7)
    buffer_load_dwordx4 v[96:99], v10, s[32:35], s67 offen offset:0 nt
    s_waitcnt vmcnt(7)
    buffer_load_dwordx4 v[100:103], v10, s[32:35], s67 offen offset:1024 nt
    s_waitcnt vmcnt(7)
    buffer_load_dwordx4 v[104:107], v10, s[32:35], s67 offen offset:2048 nt
    s_waitcnt vmcnt(7)
    buffer_load_dwordx4 v[108:111], v10, s[32:35], s67 offen offset:3072 nt
    s_waitcnt vmcnt(7)
    s_mov_b32 s69, 24576
    buffer_load_dwordx4 v[224:227], v63, s[44:47], s69 offen offset:0
    s_waitcnt vmcnt(7)
    s_mov_b32 s69, 24576
    buffer_load_dwordx4 v[228:231], v63, s[44:47], s69 offen offset:1024
    s_waitcnt vmcnt(7)
    s_mov_b32 s69, 24576
    buffer_load_dwordx4 v[232:235], v63, s[44:47], s69 offen offset:2048
    s_waitcnt vmcnt(7)
    s_mov_b32 s69, 24576
    buffer_load_dwordx4 v[236:239], v63, s[44:47], s69 offen offset:3072
    v_add_f32_dpp v37, v33, v33 row_ror:8 row_mask:0xf bank_mask:0x3
    v_add_f32_dpp v38, v34, v34 row_ror:8 row_mask:0xf bank_mask:0x3
    v_add_f32_dpp v37, v35, v35 row_ror:8 row_mask:0xf bank_mask:0xc
    v_add_f32_dpp v38, v36, v36 row_ror:8 row_mask:0xf bank_mask:0xc
    s_nop 1
    v_add_f32_dpp v56, v37, v37 row_half_mirror row_mask:0xf bank_mask:0x5
    v_add_f32_dpp v56, v38, v38 row_half_mirror row_mask:0xf bank_mask:0xa
    s_nop 1
    v_add_f32_dpp v56, v56, v56 quad_perm:[1,0,3,2] row_mask:0xf bank_mask:0xf
    s_nop 1
    v_add_f32_dpp v56, v56, v56 quad_perm:[2,3,0,1] row_mask:0xf bank_mask:0xf
    v_cvt_pk_bf16_f32 v56, v56, v56
    v_lshlrev_b32 v56, 16, v56
    v_mul_f32 v56, 0x3db504f3, v56
    v_cvt_pk_bf16_f32 v56, v56, v56
    v_lshlrev_b32 v56, 16, v56
    v_dot2_f32_bf16 v33, v112, v14, 0
    v_dot2_f32_bf16 v34, v116, v14, 0
    v_dot2_f32_bf16 v35, v120, v14, 0
    v_dot2_f32_bf16 v36, v124, v14, 0
    v_dot2c_f32_bf16 v33, v113, v15
    v_dot2c_f32_bf16 v34, v117, v15
    v_dot2c_f32_bf16 v35, v121, v15
    v_dot2c_f32_bf16 v36, v125, v15
    v_dot2c_f32_bf16 v33, v114, v16
    v_dot2c_f32_bf16 v34, v118, v16
    v_dot2c_f32_bf16 v35, v122, v16
    v_dot2c_f32_bf16 v36, v126, v16
    v_dot2c_f32_bf16 v33, v115, v17
    v_dot2c_f32_bf16 v34, v119, v17
    v_dot2c_f32_bf16 v35, v123, v17
    v_dot2c_f32_bf16 v36, v127, v17
    s_waitcnt vmcnt(7)
    buffer_load_dwordx4 v[112:115], v11, s[32:35], s67 offen offset:0 nt
    s_waitcnt vmcnt(7)
    buffer_load_dwordx4 v[116:119], v11, s[32:35], s67 offen offset:1024 nt
    s_waitcnt vmcnt(7)
    buffer_load_dwordx4 v[120:123], v11, s[32:35], s67 offen offset:2048 nt
    s_waitcnt vmcnt(7)
    buffer_load_dwordx4 v[124:127], v11, s[32:35], s67 offen offset:3072 nt
    s_waitcnt vmcnt(7)
    s_mov_b32 s69, 28672
    buffer_load_dwordx4 v[240:243], v63, s[44:47], s69 offen offset:0
    s_waitcnt vmcnt(7)
    s_mov_b32 s69, 28672
    buffer_load_dwordx4 v[244:247], v63, s[44:47], s69 offen offset:1024
    s_waitcnt vmcnt(7)
    s_mov_b32 s69, 28672
    buffer_load_dwordx4 v[248:251], v63, s[44:47], s69 offen offset:2048
    s_waitcnt vmcnt(7)
    s_mov_b32 s69, 28672
    buffer_load_dwordx4 v[252:255], v63, s[44:47], s69 offen offset:3072
    s_waitcnt vmcnt(7)
    buffer_load_dwordx4 a[96:99], v10, s[36:39], s65 offen offset:0 nt
    s_waitcnt vmcnt(7)
    buffer_load_dwordx4 a[100:103], v10, s[36:39], s65 offen offset:1024 nt
    s_waitcnt vmcnt(7)
    buffer_load_dwordx4 a[104:107], v10, s[36:39], s65 offen offset:2048 nt
    s_waitcnt vmcnt(7)
    buffer_load_dwordx4 a[108:111], v10, s[36:39], s65 offen offset:3072 nt
    v_add_f32_dpp v37, v33, v33 row_ror:8 row_mask:0xf bank_mask:0x3
    v_add_f32_dpp v38, v34, v34 row_ror:8 row_mask:0xf bank_mask:0x3
    v_add_f32_dpp v37, v35, v35 row_ror:8 row_mask:0xf bank_mask:0xc
    v_add_f32_dpp v38, v36, v36 row_ror:8 row_mask:0xf bank_mask:0xc
    s_nop 1
    v_add_f32_dpp v57, v37, v37 row_half_mirror row_mask:0xf bank_mask:0x5
    v_add_f32_dpp v57, v38, v38 row_half_mirror row_mask:0xf bank_mask:0xa
    s_nop 1
    v_add_f32_dpp v57, v57, v57 quad_perm:[1,0,3,2] row_mask:0xf bank_mask:0xf
    s_nop 1
    v_add_f32_dpp v57, v57, v57 quad_perm:[2,3,0,1] row_mask:0xf bank_mask:0xf
    v_cvt_pk_bf16_f32 v57, v57, v57
    v_lshlrev_b32 v57, 16, v57
    v_mul_f32 v57, 0x3db504f3, v57
    v_cvt_pk_bf16_f32 v57, v57, v57
    v_lshlrev_b32 v57, 16, v57
    v_dot2_f32_bf16 v33, v64, v14, 0
    v_dot2_f32_bf16 v34, v68, v14, 0
    v_dot2_f32_bf16 v35, v72, v14, 0
    v_dot2_f32_bf16 v36, v76, v14, 0
    v_dot2c_f32_bf16 v33, v65, v15
    v_dot2c_f32_bf16 v34, v69, v15
    v_dot2c_f32_bf16 v35, v73, v15
    v_dot2c_f32_bf16 v36, v77, v15
    v_dot2c_f32_bf16 v33, v66, v16
    v_dot2c_f32_bf16 v34, v70, v16
    v_dot2c_f32_bf16 v35, v74, v16
    v_dot2c_f32_bf16 v36, v78, v16
    v_dot2c_f32_bf16 v33, v67, v17
    v_dot2c_f32_bf16 v34, v71, v17
    v_dot2c_f32_bf16 v35, v75, v17
    v_dot2c_f32_bf16 v36, v79, v17
    v_add_f32_dpp v37, v33, v33 row_ror:8 row_mask:0xf bank_mask:0x3
    v_add_f32_dpp v38, v34, v34 row_ror:8 row_mask:0xf bank_mask:0x3
    v_add_f32_dpp v37, v35, v35 row_ror:8 row_mask:0xf bank_mask:0xc
    v_add_f32_dpp v38, v36, v36 row_ror:8 row_mask:0xf bank_mask:0xc
    s_nop 1
    v_add_f32_dpp v58, v37, v37 row_half_mirror row_mask:0xf bank_mask:0x5
    v_add_f32_dpp v58, v38, v38 row_half_mirror row_mask:0xf bank_mask:0xa
    s_nop 1
    v_add_f32_dpp v58, v58, v58 quad_perm:[1,0,3,2] row_mask:0xf bank_mask:0xf
    s_nop 1
    v_add_f32_dpp v58, v58, v58 quad_perm:[2,3,0,1] row_mask:0xf bank_mask:0xf
    v_cvt_pk_bf16_f32 v58, v58, v58
    v_lshlrev_b32 v58, 16, v58
    v_mul_f32 v58, 0x3db504f3, v58
    v_cvt_pk_bf16_f32 v58, v58, v58
    v_lshlrev_b32 v58, 16, v58
    v_dot2_f32_bf16 v33, v80, v14, 0
    v_dot2_f32_bf16 v34, v84, v14, 0
    v_dot2_f32_bf16 v35, v88, v14, 0
    v_dot2_f32_bf16 v36, v92, v14, 0
    v_dot2c_f32_bf16 v33, v81, v15
    v_dot2c_f32_bf16 v34, v85, v15
    v_dot2c_f32_bf16 v35, v89, v15
    v_dot2c_f32_bf16 v36, v93, v15
    v_dot2c_f32_bf16 v33, v82, v16
    v_dot2c_f32_bf16 v34, v86, v16
    v_dot2c_f32_bf16 v35, v90, v16
    v_dot2c_f32_bf16 v36, v94, v16
    v_dot2c_f32_bf16 v33, v83, v17
    v_dot2c_f32_bf16 v34, v87, v17
    v_dot2c_f32_bf16 v35, v91, v17
    v_dot2c_f32_bf16 v36, v95, v17
    v_add_f32_dpp v37, v33, v33 row_ror:8 row_mask:0xf bank_mask:0x3
    v_add_f32_dpp v38, v34, v34 row_ror:8 row_mask:0xf bank_mask:0x3
    v_add_f32_dpp v37, v35, v35 row_ror:8 row_mask:0xf bank_mask:0xc
    v_add_f32_dpp v38, v36, v36 row_ror:8 row_mask:0xf bank_mask:0xc
    s_nop 1
    v_add_f32_dpp v59, v37, v37 row_half_mirror row_mask:0xf bank_mask:0x5
    v_add_f32_dpp v59, v38, v38 row_half_mirror row_mask:0xf bank_mask:0xa
    s_nop 1
    v_add_f32_dpp v59, v59, v59 quad_perm:[1,0,3,2] row_mask:0xf bank_mask:0xf
    s_nop 1
    v_add_f32_dpp v59, v59, v59 quad_perm:[2,3,0,1] row_mask:0xf bank_mask:0xf
    v_cvt_pk_bf16_f32 v59, v59, v59
    v_lshlrev_b32 v59, 16, v59
    v_mul_f32 v59, 0x3db504f3, v59
    v_cvt_pk_bf16_f32 v59, v59, v59
    v_lshlrev_b32 v59, 16, v59
    v_dot2_f32_bf16 v33, v96, v14, 0
    v_dot2_f32_bf16 v34, v100, v14, 0
    v_dot2_f32_bf16 v35, v104, v14, 0
    v_dot2_f32_bf16 v36, v108, v14, 0
    v_dot2c_f32_bf16 v33, v97, v15
    v_dot2c_f32_bf16 v34, v101, v15
    v_dot2c_f32_bf16 v35, v105, v15
    v_dot2c_f32_bf16 v36, v109, v15
    v_dot2c_f32_bf16 v33, v98, v16
    v_dot2c_f32_bf16 v34, v102, v16
    v_dot2c_f32_bf16 v35, v106, v16
    v_dot2c_f32_bf16 v36, v110, v16
    v_dot2c_f32_bf16 v33, v99, v17
    v_dot2c_f32_bf16 v34, v103, v17
    v_dot2c_f32_bf16 v35, v107, v17
    v_dot2c_f32_bf16 v36, v111, v17
    v_add_f32_dpp v37, v33, v33 row_ror:8 row_mask:0xf bank_mask:0x3
    v_add_f32_dpp v38, v34, v34 row_ror:8 row_mask:0xf bank_mask:0x3
    v_add_f32_dpp v37, v35, v35 row_ror:8 row_mask:0xf bank_mask:0xc
    v_add_f32_dpp v38, v36, v36 row_ror:8 row_mask:0xf bank_mask:0xc
    s_nop 1
    v_add_f32_dpp v60, v37, v37 row_half_mirror row_mask:0xf bank_mask:0x5
    v_add_f32_dpp v60, v38, v38 row_half_mirror row_mask:0xf bank_mask:0xa
    s_nop 1
    v_add_f32_dpp v60, v60, v60 quad_perm:[1,0,3,2] row_mask:0xf bank_mask:0xf
    s_nop 1
    v_add_f32_dpp v60, v60, v60 quad_perm:[2,3,0,1] row_mask:0xf bank_mask:0xf
    v_cvt_pk_bf16_f32 v60, v60, v60
    v_lshlrev_b32 v60, 16, v60
    v_mul_f32 v60, 0x3db504f3, v60
    v_cvt_pk_bf16_f32 v60, v60, v60
    v_lshlrev_b32 v60, 16, v60
    v_dot2_f32_bf16 v33, v112, v14, 0
    v_dot2_f32_bf16 v34, v116, v14, 0
    v_dot2_f32_bf16 v35, v120, v14, 0
    v_dot2_f32_bf16 v36, v124, v14, 0
    v_dot2c_f32_bf16 v33, v113, v15
    v_dot2c_f32_bf16 v34, v117, v15
    v_dot2c_f32_bf16 v35, v121, v15
    v_dot2c_f32_bf16 v36, v125, v15
    v_dot2c_f32_bf16 v33, v114, v16
    v_dot2c_f32_bf16 v34, v118, v16
    v_dot2c_f32_bf16 v35, v122, v16
    v_dot2c_f32_bf16 v36, v126, v16
    v_dot2c_f32_bf16 v33, v115, v17
    v_dot2c_f32_bf16 v34, v119, v17
    v_dot2c_f32_bf16 v35, v123, v17
    v_dot2c_f32_bf16 v36, v127, v17
    v_add_f32_dpp v37, v33, v33 row_ror:8 row_mask:0xf bank_mask:0x3
    v_add_f32_dpp v38, v34, v34 row_ror:8 row_mask:0xf bank_mask:0x3
    v_add_f32_dpp v37, v35, v35 row_ror:8 row_mask:0xf bank_mask:0xc
    v_add_f32_dpp v38, v36, v36 row_ror:8 row_mask:0xf bank_mask:0xc
    s_nop 1
    v_add_f32_dpp v61, v37, v37 row_half_mirror row_mask:0xf bank_mask:0x5
    v_add_f32_dpp v61, v38, v38 row_half_mirror row_mask:0xf bank_mask:0xa
    s_nop 1
    v_add_f32_dpp v61, v61, v61 quad_perm:[1,0,3,2] row_mask:0xf bank_mask:0xf
    s_nop 1
    v_add_f32_dpp v61, v61, v61 quad_perm:[2,3,0,1] row_mask:0xf bank_mask:0xf
    v_cvt_pk_bf16_f32 v61, v61, v61
    v_lshlrev_b32 v61, 16, v61
    v_mul_f32 v61, 0x3db504f3, v61
    v_cvt_pk_bf16_f32 v61, v61, v61
    v_lshlrev_b32 v61, 16, v61
    v_max3_f32 v12, v46, v47, v48
    v_max3_f32 v12, v12, v49, v50
    v_max3_f32 v12, v12, v51, v52
    v_max3_f32 v12, v12, v53, v54
    v_max3_f32 v12, v12, v55, v56
    v_max3_f32 v12, v12, v57, v58
    v_max3_f32 v12, v12, v59, v60
    v_max_f32 v12, v12, v61
    s_nop 1
    v_max_f32_dpp v12, v12, v12 row_ror:4 row_mask:0xf bank_mask:0xf
    s_nop 1
    v_max_f32_dpp v12, v12, v12 row_ror:8 row_mask:0xf bank_mask:0xf
    v_mov_b32 v32, v12
    s_nop 1
    v_permlane16_swap_b32 v12, v32
    s_nop 0
    v_max_f32 v12, v12, v32
    v_mov_b32 v32, v12
    s_nop 1
    v_permlane32_swap_b32 v12, v32
    s_nop 0
    v_max_f32 v12, v12, v32
    s_lshl_b32 s26, s3, 2
    v_mov_b32 v32, s26
    ds_write_b32 v32, v12 offset:5120
    s_waitcnt vmcnt(7)
    buffer_load_dwordx4 a[112:115], v11, s[36:39], s65 offen offset:0 nt
    s_waitcnt vmcnt(7)
    buffer_load_dwordx4 a[116:119], v11, s[36:39], s65 offen offset:1024 nt
    s_waitcnt vmcnt(7)
    buffer_load_dwordx4 a[120:123], v11, s[36:39], s65 offen offset:2048 nt
    s_waitcnt vmcnt(7)
    buffer_load_dwordx4 a[124:127], v11, s[36:39], s65 offen offset:3072 nt
    s_waitcnt lgkmcnt(0)
    s_barrier
    v_mov_b32 v32, 0
    ds_read_b128 v[36:39], v32 offset:5120
    s_lshl_b32 s26, s22, 2
    s_add_u32 s26, s26, s3
    s_lshl_b32 s26, s26, 4
    s_add_u32 s26, s26, 4096
    s_add_u32 s60, s14, s26
    s_addc_u32 s61, s15, 0
    s_mov_b32 s62, 16
    s_mov_b32 s63, 0x00020000
    s_mov_b32 s26, 0x3fb8aa3b
    s_waitcnt lgkmcnt(0)
    v_max3_f32 v12, v36, v37, v38
    v_max_f32 v12, v12, v39
    v_mul_f32 v32, s26, v12
    v_fma_f32 v46, v46, s26, -v32
    v_fma_f32 v47, v47, s26, -v32
    v_fma_f32 v48, v48, s26, -v32
    v_fma_f32 v49, v49, s26, -v32
    v_fma_f32 v50, v50, s26, -v32
    v_fma_f32 v51, v51, s26, -v32
    v_fma_f32 v52, v52, s26, -v32
    v_fma_f32 v53, v53, s26, -v32
    v_fma_f32 v54, v54, s26, -v32
    v_fma_f32 v55, v55, s26, -v32
    v_fma_f32 v56, v56, s26, -v32
    v_fma_f32 v57, v57, s26, -v32
    v_fma_f32 v58, v58, s26, -v32
    v_fma_f32 v59, v59, s26, -v32
    v_fma_f32 v60, v60, s26, -v32
    v_fma_f32 v61, v61, s26, -v32
    v_exp_f32 v46, v46
    v_exp_f32 v47, v47
    v_exp_f32 v48, v48
    v_exp_f32 v49, v49
    v_exp_f32 v50, v50
    v_exp_f32 v51, v51
    v_exp_f32 v52, v52
    v_exp_f32 v53, v53
    v_exp_f32 v54, v54
    v_exp_f32 v55, v55
    v_exp_f32 v56, v56
    v_exp_f32 v57, v57
    v_exp_f32 v58, v58
    v_exp_f32 v59, v59
    v_exp_f32 v60, v60
    v_exp_f32 v61, v61
    v_mov_b32 v33, s73
    v_add_f32 v13, v46, v47
    v_add_f32 v37, v48, v49
    v_add_f32 v13, v13, v50
    v_add_f32 v37, v37, v51
    v_add_f32 v13, v13, v52
    v_add_f32 v37, v37, v53
    v_add_f32 v13, v13, v54
    v_add_f32 v37, v37, v55
    v_add_f32 v13, v13, v56
    v_add_f32 v37, v37, v57
    v_add_f32 v13, v13, v58
    v_add_f32 v37, v37, v59
    v_add_f32 v13, v13, v60
    v_add_f32 v37, v37, v61
    v_add_f32 v13, v13, v37
    v_cvt_pk_bf16_f32 v46, v46, v46
    v_cvt_pk_bf16_f32 v47, v47, v47
    v_cvt_pk_bf16_f32 v48, v48, v48
    v_cvt_pk_bf16_f32 v49, v49, v49
    v_add_f32_dpp v13, v13, v13 row_ror:4 row_mask:0xf bank_mask:0xf
    v_cvt_pk_bf16_f32 v50, v50, v50
    v_cvt_pk_bf16_f32 v51, v51, v51
    v_cvt_pk_bf16_f32 v52, v52, v52
    v_cvt_pk_bf16_f32 v53, v53, v53
    v_add_f32_dpp v13, v13, v13 row_ror:8 row_mask:0xf bank_mask:0xf
    v_cvt_pk_bf16_f32 v54, v54, v54
    v_cvt_pk_bf16_f32 v55, v55, v55
    v_cvt_pk_bf16_f32 v56, v56, v56
    v_cvt_pk_bf16_f32 v57, v57, v57
    v_cvt_pk_bf16_f32 v58, v58, v58
    v_cvt_pk_bf16_f32 v59, v59, v59
    v_cvt_pk_bf16_f32 v60, v60, v60
    v_cvt_pk_bf16_f32 v61, v61, v61
    v_mov_b32 v37, v13
    s_nop 1
    v_permlane16_swap_b32 v13, v37
    s_nop 0
    v_add_f32 v13, v13, v37
    v_mov_b32 v37, v13
    s_nop 1
    v_permlane32_swap_b32 v13, v37
    s_nop 0
    v_add_f32 v13, v13, v37
    v_mov_b32 v32, v12
    v_mov_b32 v34, v13
    v_mov_b32 v35, s74
    v_lshlrev_b32 v36, 4, v1
    buffer_store_dwordx4 v[32:35], v36, s[60:63], 0 offen sc0 sc1
    s_lshl_b32 s26, s20, 9
    s_add_u32 s26, s26, 4096
    s_add_u32 s32, s14, s26
    s_addc_u32 s33, s15, 0
    s_mov_b32 s34, 512
    s_mov_b32 s35, 0x00020000
    v_and_b32 v105, 31, v1
    v_lshlrev_b32 v105, 4, v105
    s_waitcnt vmcnt(7)
    buffer_load_dwordx4 a[128:131], v8, s[36:39], s66 offen offset:0 nt
    s_waitcnt vmcnt(7)
    buffer_load_dwordx4 a[132:135], v8, s[36:39], s66 offen offset:1024 nt
    s_waitcnt vmcnt(7)
    buffer_load_dwordx4 a[136:139], v8, s[36:39], s66 offen offset:2048 nt
    s_waitcnt vmcnt(7)
    buffer_load_dwordx4 a[140:143], v8, s[36:39], s66 offen offset:3072 nt
    s_waitcnt vmcnt(7)
    buffer_load_dwordx4 a[144:147], v9, s[36:39], s66 offen offset:0 nt
    s_waitcnt vmcnt(7)
    buffer_load_dwordx4 a[148:151], v9, s[36:39], s66 offen offset:1024 nt
    s_waitcnt vmcnt(7)
    buffer_load_dwordx4 a[152:155], v9, s[36:39], s66 offen offset:2048 nt
    s_waitcnt vmcnt(7)
    buffer_load_dwordx4 a[156:159], v9, s[36:39], s66 offen offset:3072 nt
    s_waitcnt vmcnt(7)
    buffer_load_dwordx4 a[160:163], v10, s[36:39], s66 offen offset:0 nt
    s_waitcnt vmcnt(7)
    buffer_load_dwordx4 a[164:167], v10, s[36:39], s66 offen offset:1024 nt
    s_waitcnt vmcnt(7)
    buffer_load_dwordx4 a[168:171], v10, s[36:39], s66 offen offset:2048 nt
    s_waitcnt vmcnt(7)
    buffer_load_dwordx4 a[172:175], v10, s[36:39], s66 offen offset:3072 nt
    s_waitcnt vmcnt(7)
    buffer_load_dwordx4 a[176:179], v11, s[36:39], s66 offen offset:0 nt
    s_waitcnt vmcnt(7)
    buffer_load_dwordx4 a[180:183], v11, s[36:39], s66 offen offset:1024 nt
    s_waitcnt vmcnt(7)
    buffer_load_dwordx4 a[184:187], v11, s[36:39], s66 offen offset:2048 nt
    s_waitcnt vmcnt(7)
    buffer_load_dwordx4 a[188:191], v11, s[36:39], s66 offen offset:3072 nt
    s_waitcnt vmcnt(7)
    buffer_load_dwordx4 a[192:195], v8, s[36:39], s67 offen offset:0 nt
    s_waitcnt vmcnt(7)
    buffer_load_dwordx4 a[196:199], v8, s[36:39], s67 offen offset:1024 nt
    s_waitcnt vmcnt(7)
    buffer_load_dwordx4 a[200:203], v8, s[36:39], s67 offen offset:2048 nt
    s_waitcnt vmcnt(7)
    buffer_load_dwordx4 a[204:207], v8, s[36:39], s67 offen offset:3072 nt
    s_waitcnt vmcnt(7)
    buffer_load_dwordx4 a[208:211], v9, s[36:39], s67 offen offset:0 nt
    s_waitcnt vmcnt(7)
    buffer_load_dwordx4 a[212:215], v9, s[36:39], s67 offen offset:1024 nt
    s_waitcnt vmcnt(7)
    buffer_load_dwordx4 a[216:219], v9, s[36:39], s67 offen offset:2048 nt
    s_waitcnt vmcnt(7)
    buffer_load_dwordx4 a[220:223], v9, s[36:39], s67 offen offset:3072 nt
    buffer_load_dwordx4 v[64:67], v105, s[32:35], 0 offen sc0 sc1
    s_waitcnt vmcnt(7)
    buffer_load_dwordx4 a[224:227], v10, s[36:39], s67 offen offset:0 nt
    s_waitcnt vmcnt(7)
    buffer_load_dwordx4 a[228:231], v10, s[36:39], s67 offen offset:1024 nt
    s_waitcnt vmcnt(7)
    buffer_load_dwordx4 a[232:235], v10, s[36:39], s67 offen offset:2048 nt
    s_waitcnt vmcnt(7)
    buffer_load_dwordx4 a[236:239], v10, s[36:39], s67 offen offset:3072 nt
    s_waitcnt vmcnt(7)
    buffer_load_dwordx4 a[240:243], v11, s[36:39], s67 offen offset:0 nt
    s_waitcnt vmcnt(7)
    buffer_load_dwordx4 a[244:247], v11, s[36:39], s67 offen offset:1024 nt
    s_waitcnt vmcnt(7)
    buffer_load_dwordx4 a[248:251], v11, s[36:39], s67 offen offset:2048 nt
    s_waitcnt vmcnt(7)
    buffer_load_dwordx4 a[252:255], v11, s[36:39], s67 offen offset:3072 nt
    v_and_b32_dpp v20, v46, v4 row_newbcast:0 row_mask:0xf bank_mask:0xf
    v_and_b32_dpp v21, v46, v5 row_newbcast:0 row_mask:0xf bank_mask:0xf
    v_and_b32_dpp v22, v46, v6 row_newbcast:0 row_mask:0xf bank_mask:0xf
    v_and_b32_dpp v23, v46, v7 row_newbcast:0 row_mask:0xf bank_mask:0xf
    v_and_b32_dpp v24, v46, v4 row_newbcast:4 row_mask:0xf bank_mask:0xf
    v_and_b32_dpp v25, v46, v5 row_newbcast:4 row_mask:0xf bank_mask:0xf
    v_and_b32_dpp v26, v46, v6 row_newbcast:4 row_mask:0xf bank_mask:0xf
    v_and_b32_dpp v27, v46, v7 row_newbcast:4 row_mask:0xf bank_mask:0xf
    v_mfma_f32_16x16x32_bf16 v[28:31], v[20:23], a[0:3], 0
    v_and_b32_dpp v20, v46, v4 row_newbcast:8 row_mask:0xf bank_mask:0xf
    v_and_b32_dpp v21, v46, v5 row_newbcast:8 row_mask:0xf bank_mask:0xf
    v_and_b32_dpp v22, v46, v6 row_newbcast:8 row_mask:0xf bank_mask:0xf
    v_and_b32_dpp v23, v46, v7 row_newbcast:8 row_mask:0xf bank_mask:0xf
    v_mfma_f32_16x16x32_bf16 v[28:31], v[24:27], a[4:7], v[28:31]
    v_and_b32_dpp v24, v46, v4 row_newbcast:12 row_mask:0xf bank_mask:0xf
    v_and_b32_dpp v25, v46, v5 row_newbcast:12 row_mask:0xf bank_mask:0xf
    v_and_b32_dpp v26, v46, v6 row_newbcast:12 row_mask:0xf bank_mask:0xf
    v_and_b32_dpp v27, v46, v7 row_newbcast:12 row_mask:0xf bank_mask:0xf
    v_mfma_f32_16x16x32_bf16 v[28:31], v[20:23], a[8:11], v[28:31]
    v_and_b32_dpp v20, v47, v4 row_newbcast:0 row_mask:0xf bank_mask:0xf
    v_and_b32_dpp v21, v47, v5 row_newbcast:0 row_mask:0xf bank_mask:0xf
    v_and_b32_dpp v22, v47, v6 row_newbcast:0 row_mask:0xf bank_mask:0xf
    v_and_b32_dpp v23, v47, v7 row_newbcast:0 row_mask:0xf bank_mask:0xf
    v_mfma_f32_16x16x32_bf16 v[28:31], v[24:27], a[12:15], v[28:31]
    v_and_b32_dpp v24, v47, v4 row_newbcast:4 row_mask:0xf bank_mask:0xf
    v_and_b32_dpp v25, v47, v5 row_newbcast:4 row_mask:0xf bank_mask:0xf
    v_and_b32_dpp v26, v47, v6 row_newbcast:4 row_mask:0xf bank_mask:0xf
    v_and_b32_dpp v27, v47, v7 row_newbcast:4 row_mask:0xf bank_mask:0xf
    v_mfma_f32_16x16x32_bf16 v[28:31], v[20:23], a[16:19], v[28:31]
    v_and_b32_dpp v20, v47, v4 row_newbcast:8 row_mask:0xf bank_mask:0xf
    v_and_b32_dpp v21, v47, v5 row_newbcast:8 row_mask:0xf bank_mask:0xf
    v_and_b32_dpp v22, v47, v6 row_newbcast:8 row_mask:0xf bank_mask:0xf
    v_and_b32_dpp v23, v47, v7 row_newbcast:8 row_mask:0xf bank_mask:0xf
    v_mfma_f32_16x16x32_bf16 v[28:31], v[24:27], a[20:23], v[28:31]
    v_and_b32_dpp v24, v47, v4 row_newbcast:12 row_mask:0xf bank_mask:0xf
    v_and_b32_dpp v25, v47, v5 row_newbcast:12 row_mask:0xf bank_mask:0xf
    v_and_b32_dpp v26, v47, v6 row_newbcast:12 row_mask:0xf bank_mask:0xf
    v_and_b32_dpp v27, v47, v7 row_newbcast:12 row_mask:0xf bank_mask:0xf
    v_mfma_f32_16x16x32_bf16 v[28:31], v[20:23], a[24:27], v[28:31]
    v_and_b32_dpp v20, v48, v4 row_newbcast:0 row_mask:0xf bank_mask:0xf
    v_and_b32_dpp v21, v48, v5 row_newbcast:0 row_mask:0xf bank_mask:0xf
    v_and_b32_dpp v22, v48, v6 row_newbcast:0 row_mask:0xf bank_mask:0xf
    v_and_b32_dpp v23, v48, v7 row_newbcast:0 row_mask:0xf bank_mask:0xf
    v_mfma_f32_16x16x32_bf16 v[28:31], v[24:27], a[28:31], v[28:31]
    v_and_b32_dpp v24, v48, v4 row_newbcast:4 row_mask:0xf bank_mask:0xf
    v_and_b32_dpp v25, v48, v5 row_newbcast:4 row_mask:0xf bank_mask:0xf
    v_and_b32_dpp v26, v48, v6 row_newbcast:4 row_mask:0xf bank_mask:0xf
    v_and_b32_dpp v27, v48, v7 row_newbcast:4 row_mask:0xf bank_mask:0xf
    v_mfma_f32_16x16x32_bf16 v[28:31], v[20:23], a[32:35], v[28:31]
    v_lshrrev_b32 v32, 3, v0
    v_and_b32 v33, 7, v0
    v_lshlrev_b32 v33, 4, v33
    v_lshl_add_u32 v104, v32, 12, v33
    v_cmp_gt_u32 vcc, 12, v32
    v_mov_b32 v108, 0
    s_nop 0
    v_cndmask_b32 v108, v108, -1, vcc
    s_sub_u32 s24, s2, 224
    s_cmp_lt_u32 s24, 32
    s_cselect_b32 s21, 1, 0
    s_cselect_b32 s24, s24, 0
    s_lshl_b32 s26, s24, 7
    s_add_u32 s27, s26, 1081344
    s_sub_u32 s24, 704512, s26
    s_mul_i32 s24, s24, s21
    s_add_u32 s48, s14, s27
    s_addc_u32 s49, s15, 0
    s_mov_b32 s50, s24
    s_mov_b32 s51, 0x00020000
    s_mov_b32 s26, 0
    buffer_load_dwordx4 v[68:71], v104, s[48:51], s26 offen sc0 sc1
    s_mov_b32 s26, 131072
    buffer_load_dwordx4 v[72:75], v104, s[48:51], s26 offen sc0 sc1
    s_mov_b32 s26, 262144
    buffer_load_dwordx4 v[76:79], v104, s[48:51], s26 offen sc0 sc1
    s_mov_b32 s26, 393216
    buffer_load_dwordx4 v[80:83], v104, s[48:51], s26 offen sc0 sc1
    s_mov_b32 s26, 524288
    buffer_load_dwordx4 v[84:87], v104, s[48:51], s26 offen sc0 sc1
    s_mov_b32 s26, 655360
    buffer_load_dwordx4 v[88:91], v104, s[48:51], s26 offen sc0 sc1
    v_and_b32 v40, 1, v3
    v_lshlrev_b32 v40, 4, v40
    v_lshl_add_u32 v40, v2, 5, v40
    s_lshl_b32 s26, s3, 9
    v_add_u32 v40, s26, v40
    v_lshlrev_b32 v41, 3, v1
    v_add_u32 v33, s26, v41
    v_lshlrev_b32 v34, 7, v3
    v_add_u32 v34, s26, v34
    v_mov_b32 v37, s73
    v_mov_b32 v39, s74
    v_and_b32 v42, 1, v3
    v_lshlrev_b32 v42, 5, v42
    v_lshl_add_u32 v42, v2, 6, v42
    v_lshrrev_b32 v43, 1, v3
    v_lshl_add_u32 v42, v43, 4, v42
    s_lshl_b32 s26, s22, 12
    s_lshl_b32 s27, s3, 10
    s_add_u32 s26, s26, s27
    s_add_u32 s26, s26, 32768
    s_add_u32 s56, s14, s26
    s_addc_u32 s57, s15, 0
    s_mov_b32 s58, 1024
    s_mov_b32 s59, 0x00020000
    v_cmp_lt_u32 s[96:97], v1, 32
    v_and_b32_dpp v20, v48, v4 row_newbcast:8 row_mask:0xf bank_mask:0xf
    v_and_b32_dpp v21, v48, v5 row_newbcast:8 row_mask:0xf bank_mask:0xf
    v_and_b32_dpp v22, v48, v6 row_newbcast:8 row_mask:0xf bank_mask:0xf
    v_and_b32_dpp v23, v48, v7 row_newbcast:8 row_mask:0xf bank_mask:0xf
    v_mfma_f32_16x16x32_bf16 v[28:31], v[24:27], a[36:39], v[28:31]
    v_and_b32_dpp v24, v48, v4 row_newbcast:12 row_mask:0xf bank_mask:0xf
    v_and_b32_dpp v25, v48, v5 row_newbcast:12 row_mask:0xf bank_mask:0xf
    v_and_b32_dpp v26, v48, v6 row_newbcast:12 row_mask:0xf bank_mask:0xf
    v_and_b32_dpp v27, v48, v7 row_newbcast:12 row_mask:0xf bank_mask:0xf
    v_mfma_f32_16x16x32_bf16 v[28:31], v[20:23], a[40:43], v[28:31]
    v_and_b32_dpp v20, v49, v4 row_newbcast:0 row_mask:0xf bank_mask:0xf
    v_and_b32_dpp v21, v49, v5 row_newbcast:0 row_mask:0xf bank_mask:0xf
    v_and_b32_dpp v22, v49, v6 row_newbcast:0 row_mask:0xf bank_mask:0xf
    v_and_b32_dpp v23, v49, v7 row_newbcast:0 row_mask:0xf bank_mask:0xf
    v_mfma_f32_16x16x32_bf16 v[28:31], v[24:27], a[44:47], v[28:31]
    v_and_b32_dpp v24, v49, v4 row_newbcast:4 row_mask:0xf bank_mask:0xf
    v_and_b32_dpp v25, v49, v5 row_newbcast:4 row_mask:0xf bank_mask:0xf
    v_and_b32_dpp v26, v49, v6 row_newbcast:4 row_mask:0xf bank_mask:0xf
    v_and_b32_dpp v27, v49, v7 row_newbcast:4 row_mask:0xf bank_mask:0xf
    v_mfma_f32_16x16x32_bf16 v[28:31], v[20:23], a[48:51], v[28:31]
    v_and_b32_dpp v20, v49, v4 row_newbcast:8 row_mask:0xf bank_mask:0xf
    v_and_b32_dpp v21, v49, v5 row_newbcast:8 row_mask:0xf bank_mask:0xf
    v_and_b32_dpp v22, v49, v6 row_newbcast:8 row_mask:0xf bank_mask:0xf
    v_and_b32_dpp v23, v49, v7 row_newbcast:8 row_mask:0xf bank_mask:0xf
    v_mfma_f32_16x16x32_bf16 v[28:31], v[24:27], a[52:55], v[28:31]
    v_and_b32_dpp v24, v49, v4 row_newbcast:12 row_mask:0xf bank_mask:0xf
    v_and_b32_dpp v25, v49, v5 row_newbcast:12 row_mask:0xf bank_mask:0xf
    v_and_b32_dpp v26, v49, v6 row_newbcast:12 row_mask:0xf bank_mask:0xf
    v_and_b32_dpp v27, v49, v7 row_newbcast:12 row_mask:0xf bank_mask:0xf
    v_mfma_f32_16x16x32_bf16 v[28:31], v[20:23], a[56:59], v[28:31]
    v_and_b32_dpp v20, v50, v4 row_newbcast:0 row_mask:0xf bank_mask:0xf
    v_and_b32_dpp v21, v50, v5 row_newbcast:0 row_mask:0xf bank_mask:0xf
    v_and_b32_dpp v22, v50, v6 row_newbcast:0 row_mask:0xf bank_mask:0xf
    v_and_b32_dpp v23, v50, v7 row_newbcast:0 row_mask:0xf bank_mask:0xf
    v_mfma_f32_16x16x32_bf16 v[28:31], v[24:27], a[60:63], v[28:31]
    v_and_b32_dpp v24, v50, v4 row_newbcast:4 row_mask:0xf bank_mask:0xf
    v_and_b32_dpp v25, v50, v5 row_newbcast:4 row_mask:0xf bank_mask:0xf
    v_and_b32_dpp v26, v50, v6 row_newbcast:4 row_mask:0xf bank_mask:0xf
    v_and_b32_dpp v27, v50, v7 row_newbcast:4 row_mask:0xf bank_mask:0xf
    v_mfma_f32_16x16x32_bf16 v[28:31], v[20:23], a[64:67], v[28:31]
    v_and_b32_dpp v20, v50, v4 row_newbcast:8 row_mask:0xf bank_mask:0xf
    v_and_b32_dpp v21, v50, v5 row_newbcast:8 row_mask:0xf bank_mask:0xf
    v_and_b32_dpp v22, v50, v6 row_newbcast:8 row_mask:0xf bank_mask:0xf
    v_and_b32_dpp v23, v50, v7 row_newbcast:8 row_mask:0xf bank_mask:0xf
    v_mfma_f32_16x16x32_bf16 v[28:31], v[24:27], a[68:71], v[28:31]
    v_and_b32_dpp v24, v50, v4 row_newbcast:12 row_mask:0xf bank_mask:0xf
    v_and_b32_dpp v25, v50, v5 row_newbcast:12 row_mask:0xf bank_mask:0xf
    v_and_b32_dpp v26, v50, v6 row_newbcast:12 row_mask:0xf bank_mask:0xf
    v_and_b32_dpp v27, v50, v7 row_newbcast:12 row_mask:0xf bank_mask:0xf
    v_mfma_f32_16x16x32_bf16 v[28:31], v[20:23], a[72:75], v[28:31]
    v_and_b32_dpp v20, v51, v4 row_newbcast:0 row_mask:0xf bank_mask:0xf
    v_and_b32_dpp v21, v51, v5 row_newbcast:0 row_mask:0xf bank_mask:0xf
    v_and_b32_dpp v22, v51, v6 row_newbcast:0 row_mask:0xf bank_mask:0xf
    v_and_b32_dpp v23, v51, v7 row_newbcast:0 row_mask:0xf bank_mask:0xf
    v_mfma_f32_16x16x32_bf16 v[28:31], v[24:27], a[76:79], v[28:31]
    v_and_b32_dpp v24, v51, v4 row_newbcast:4 row_mask:0xf bank_mask:0xf
    v_and_b32_dpp v25, v51, v5 row_newbcast:4 row_mask:0xf bank_mask:0xf
    v_and_b32_dpp v26, v51, v6 row_newbcast:4 row_mask:0xf bank_mask:0xf
    v_and_b32_dpp v27, v51, v7 row_newbcast:4 row_mask:0xf bank_mask:0xf
    v_mfma_f32_16x16x32_bf16 v[28:31], v[20:23], a[80:83], v[28:31]
    v_and_b32_dpp v20, v51, v4 row_newbcast:8 row_mask:0xf bank_mask:0xf
    v_and_b32_dpp v21, v51, v5 row_newbcast:8 row_mask:0xf bank_mask:0xf
    v_and_b32_dpp v22, v51, v6 row_newbcast:8 row_mask:0xf bank_mask:0xf
    v_and_b32_dpp v23, v51, v7 row_newbcast:8 row_mask:0xf bank_mask:0xf
    v_mfma_f32_16x16x32_bf16 v[28:31], v[24:27], a[84:87], v[28:31]
    v_and_b32_dpp v24, v51, v4 row_newbcast:12 row_mask:0xf bank_mask:0xf
    v_and_b32_dpp v25, v51, v5 row_newbcast:12 row_mask:0xf bank_mask:0xf
    v_and_b32_dpp v26, v51, v6 row_newbcast:12 row_mask:0xf bank_mask:0xf
    v_and_b32_dpp v27, v51, v7 row_newbcast:12 row_mask:0xf bank_mask:0xf
    v_mfma_f32_16x16x32_bf16 v[28:31], v[20:23], a[88:91], v[28:31]
    v_and_b32_dpp v20, v52, v4 row_newbcast:0 row_mask:0xf bank_mask:0xf
    v_and_b32_dpp v21, v52, v5 row_newbcast:0 row_mask:0xf bank_mask:0xf
    v_and_b32_dpp v22, v52, v6 row_newbcast:0 row_mask:0xf bank_mask:0xf
    v_and_b32_dpp v23, v52, v7 row_newbcast:0 row_mask:0xf bank_mask:0xf
    v_mfma_f32_16x16x32_bf16 v[28:31], v[24:27], a[92:95], v[28:31]
    v_and_b32_dpp v24, v52, v4 row_newbcast:4 row_mask:0xf bank_mask:0xf
    v_and_b32_dpp v25, v52, v5 row_newbcast:4 row_mask:0xf bank_mask:0xf
    v_and_b32_dpp v26, v52, v6 row_newbcast:4 row_mask:0xf bank_mask:0xf
    v_and_b32_dpp v27, v52, v7 row_newbcast:4 row_mask:0xf bank_mask:0xf
    v_mfma_f32_16x16x32_bf16 v[28:31], v[20:23], a[96:99], v[28:31]
    v_and_b32_dpp v20, v52, v4 row_newbcast:8 row_mask:0xf bank_mask:0xf
    v_and_b32_dpp v21, v52, v5 row_newbcast:8 row_mask:0xf bank_mask:0xf
    v_and_b32_dpp v22, v52, v6 row_newbcast:8 row_mask:0xf bank_mask:0xf
    v_and_b32_dpp v23, v52, v7 row_newbcast:8 row_mask:0xf bank_mask:0xf
    v_mfma_f32_16x16x32_bf16 v[28:31], v[24:27], a[100:103], v[28:31]
    v_and_b32_dpp v24, v52, v4 row_newbcast:12 row_mask:0xf bank_mask:0xf
    v_and_b32_dpp v25, v52, v5 row_newbcast:12 row_mask:0xf bank_mask:0xf
    v_and_b32_dpp v26, v52, v6 row_newbcast:12 row_mask:0xf bank_mask:0xf
    v_and_b32_dpp v27, v52, v7 row_newbcast:12 row_mask:0xf bank_mask:0xf
    v_mfma_f32_16x16x32_bf16 v[28:31], v[20:23], a[104:107], v[28:31]
    v_and_b32_dpp v20, v53, v4 row_newbcast:0 row_mask:0xf bank_mask:0xf
    v_and_b32_dpp v21, v53, v5 row_newbcast:0 row_mask:0xf bank_mask:0xf
    v_and_b32_dpp v22, v53, v6 row_newbcast:0 row_mask:0xf bank_mask:0xf
    v_and_b32_dpp v23, v53, v7 row_newbcast:0 row_mask:0xf bank_mask:0xf
    v_mfma_f32_16x16x32_bf16 v[28:31], v[24:27], a[108:111], v[28:31]
    v_and_b32_dpp v24, v53, v4 row_newbcast:4 row_mask:0xf bank_mask:0xf
    v_and_b32_dpp v25, v53, v5 row_newbcast:4 row_mask:0xf bank_mask:0xf
    v_and_b32_dpp v26, v53, v6 row_newbcast:4 row_mask:0xf bank_mask:0xf
    v_and_b32_dpp v27, v53, v7 row_newbcast:4 row_mask:0xf bank_mask:0xf
    v_mfma_f32_16x16x32_bf16 v[28:31], v[20:23], a[112:115], v[28:31]
    v_and_b32_dpp v20, v53, v4 row_newbcast:8 row_mask:0xf bank_mask:0xf
    v_and_b32_dpp v21, v53, v5 row_newbcast:8 row_mask:0xf bank_mask:0xf
    v_and_b32_dpp v22, v53, v6 row_newbcast:8 row_mask:0xf bank_mask:0xf
    v_and_b32_dpp v23, v53, v7 row_newbcast:8 row_mask:0xf bank_mask:0xf
    v_mfma_f32_16x16x32_bf16 v[28:31], v[24:27], a[116:119], v[28:31]
    v_and_b32_dpp v24, v53, v4 row_newbcast:12 row_mask:0xf bank_mask:0xf
    v_and_b32_dpp v25, v53, v5 row_newbcast:12 row_mask:0xf bank_mask:0xf
    v_and_b32_dpp v26, v53, v6 row_newbcast:12 row_mask:0xf bank_mask:0xf
    v_and_b32_dpp v27, v53, v7 row_newbcast:12 row_mask:0xf bank_mask:0xf
    v_mfma_f32_16x16x32_bf16 v[28:31], v[20:23], a[120:123], v[28:31]
    v_and_b32_dpp v20, v54, v4 row_newbcast:0 row_mask:0xf bank_mask:0xf
    v_and_b32_dpp v21, v54, v5 row_newbcast:0 row_mask:0xf bank_mask:0xf
    v_and_b32_dpp v22, v54, v6 row_newbcast:0 row_mask:0xf bank_mask:0xf
    v_and_b32_dpp v23, v54, v7 row_newbcast:0 row_mask:0xf bank_mask:0xf
    v_mfma_f32_16x16x32_bf16 v[28:31], v[24:27], a[124:127], v[28:31]
    v_and_b32_dpp v24, v54, v4 row_newbcast:4 row_mask:0xf bank_mask:0xf
    v_and_b32_dpp v25, v54, v5 row_newbcast:4 row_mask:0xf bank_mask:0xf
    v_and_b32_dpp v26, v54, v6 row_newbcast:4 row_mask:0xf bank_mask:0xf
    v_and_b32_dpp v27, v54, v7 row_newbcast:4 row_mask:0xf bank_mask:0xf
    v_mfma_f32_16x16x32_bf16 v[28:31], v[20:23], a[128:131], v[28:31]
    v_and_b32_dpp v20, v54, v4 row_newbcast:8 row_mask:0xf bank_mask:0xf
    v_and_b32_dpp v21, v54, v5 row_newbcast:8 row_mask:0xf bank_mask:0xf
    v_and_b32_dpp v22, v54, v6 row_newbcast:8 row_mask:0xf bank_mask:0xf
    v_and_b32_dpp v23, v54, v7 row_newbcast:8 row_mask:0xf bank_mask:0xf
    v_mfma_f32_16x16x32_bf16 v[28:31], v[24:27], a[132:135], v[28:31]
    v_and_b32_dpp v24, v54, v4 row_newbcast:12 row_mask:0xf bank_mask:0xf
    v_and_b32_dpp v25, v54, v5 row_newbcast:12 row_mask:0xf bank_mask:0xf
    v_and_b32_dpp v26, v54, v6 row_newbcast:12 row_mask:0xf bank_mask:0xf
    v_and_b32_dpp v27, v54, v7 row_newbcast:12 row_mask:0xf bank_mask:0xf
    v_mfma_f32_16x16x32_bf16 v[28:31], v[20:23], a[136:139], v[28:31]
    v_and_b32_dpp v20, v55, v4 row_newbcast:0 row_mask:0xf bank_mask:0xf
    v_and_b32_dpp v21, v55, v5 row_newbcast:0 row_mask:0xf bank_mask:0xf
    v_and_b32_dpp v22, v55, v6 row_newbcast:0 row_mask:0xf bank_mask:0xf
    v_and_b32_dpp v23, v55, v7 row_newbcast:0 row_mask:0xf bank_mask:0xf
    v_mfma_f32_16x16x32_bf16 v[28:31], v[24:27], a[140:143], v[28:31]
    v_and_b32_dpp v24, v55, v4 row_newbcast:4 row_mask:0xf bank_mask:0xf
    v_and_b32_dpp v25, v55, v5 row_newbcast:4 row_mask:0xf bank_mask:0xf
    v_and_b32_dpp v26, v55, v6 row_newbcast:4 row_mask:0xf bank_mask:0xf
    v_and_b32_dpp v27, v55, v7 row_newbcast:4 row_mask:0xf bank_mask:0xf
    v_mfma_f32_16x16x32_bf16 v[28:31], v[20:23], a[144:147], v[28:31]
    v_and_b32_dpp v20, v55, v4 row_newbcast:8 row_mask:0xf bank_mask:0xf
    v_and_b32_dpp v21, v55, v5 row_newbcast:8 row_mask:0xf bank_mask:0xf
    v_and_b32_dpp v22, v55, v6 row_newbcast:8 row_mask:0xf bank_mask:0xf
    v_and_b32_dpp v23, v55, v7 row_newbcast:8 row_mask:0xf bank_mask:0xf
    v_mfma_f32_16x16x32_bf16 v[28:31], v[24:27], a[148:151], v[28:31]
    v_and_b32_dpp v24, v55, v4 row_newbcast:12 row_mask:0xf bank_mask:0xf
    v_and_b32_dpp v25, v55, v5 row_newbcast:12 row_mask:0xf bank_mask:0xf
    v_and_b32_dpp v26, v55, v6 row_newbcast:12 row_mask:0xf bank_mask:0xf
    v_and_b32_dpp v27, v55, v7 row_newbcast:12 row_mask:0xf bank_mask:0xf
    v_mfma_f32_16x16x32_bf16 v[28:31], v[20:23], a[152:155], v[28:31]
    v_and_b32_dpp v20, v56, v4 row_newbcast:0 row_mask:0xf bank_mask:0xf
    v_and_b32_dpp v21, v56, v5 row_newbcast:0 row_mask:0xf bank_mask:0xf
    v_and_b32_dpp v22, v56, v6 row_newbcast:0 row_mask:0xf bank_mask:0xf
    v_and_b32_dpp v23, v56, v7 row_newbcast:0 row_mask:0xf bank_mask:0xf
    v_mfma_f32_16x16x32_bf16 v[28:31], v[24:27], a[156:159], v[28:31]
    v_and_b32_dpp v24, v56, v4 row_newbcast:4 row_mask:0xf bank_mask:0xf
    v_and_b32_dpp v25, v56, v5 row_newbcast:4 row_mask:0xf bank_mask:0xf
    v_and_b32_dpp v26, v56, v6 row_newbcast:4 row_mask:0xf bank_mask:0xf
    v_and_b32_dpp v27, v56, v7 row_newbcast:4 row_mask:0xf bank_mask:0xf
    v_mfma_f32_16x16x32_bf16 v[28:31], v[20:23], a[160:163], v[28:31]
    v_and_b32_dpp v20, v56, v4 row_newbcast:8 row_mask:0xf bank_mask:0xf
    v_and_b32_dpp v21, v56, v5 row_newbcast:8 row_mask:0xf bank_mask:0xf
    v_and_b32_dpp v22, v56, v6 row_newbcast:8 row_mask:0xf bank_mask:0xf
    v_and_b32_dpp v23, v56, v7 row_newbcast:8 row_mask:0xf bank_mask:0xf
    v_mfma_f32_16x16x32_bf16 v[28:31], v[24:27], a[164:167], v[28:31]
    v_and_b32_dpp v24, v56, v4 row_newbcast:12 row_mask:0xf bank_mask:0xf
    v_and_b32_dpp v25, v56, v5 row_newbcast:12 row_mask:0xf bank_mask:0xf
    v_and_b32_dpp v26, v56, v6 row_newbcast:12 row_mask:0xf bank_mask:0xf
    v_and_b32_dpp v27, v56, v7 row_newbcast:12 row_mask:0xf bank_mask:0xf
    v_mfma_f32_16x16x32_bf16 v[28:31], v[20:23], a[168:171], v[28:31]
    v_and_b32_dpp v20, v57, v4 row_newbcast:0 row_mask:0xf bank_mask:0xf
    v_and_b32_dpp v21, v57, v5 row_newbcast:0 row_mask:0xf bank_mask:0xf
    v_and_b32_dpp v22, v57, v6 row_newbcast:0 row_mask:0xf bank_mask:0xf
    v_and_b32_dpp v23, v57, v7 row_newbcast:0 row_mask:0xf bank_mask:0xf
    v_mfma_f32_16x16x32_bf16 v[28:31], v[24:27], a[172:175], v[28:31]
    v_and_b32_dpp v24, v57, v4 row_newbcast:4 row_mask:0xf bank_mask:0xf
    v_and_b32_dpp v25, v57, v5 row_newbcast:4 row_mask:0xf bank_mask:0xf
    v_and_b32_dpp v26, v57, v6 row_newbcast:4 row_mask:0xf bank_mask:0xf
    v_and_b32_dpp v27, v57, v7 row_newbcast:4 row_mask:0xf bank_mask:0xf
    v_mfma_f32_16x16x32_bf16 v[28:31], v[20:23], a[176:179], v[28:31]
    v_and_b32_dpp v20, v57, v4 row_newbcast:8 row_mask:0xf bank_mask:0xf
    v_and_b32_dpp v21, v57, v5 row_newbcast:8 row_mask:0xf bank_mask:0xf
    v_and_b32_dpp v22, v57, v6 row_newbcast:8 row_mask:0xf bank_mask:0xf
    v_and_b32_dpp v23, v57, v7 row_newbcast:8 row_mask:0xf bank_mask:0xf
    v_mfma_f32_16x16x32_bf16 v[28:31], v[24:27], a[180:183], v[28:31]
    v_and_b32_dpp v24, v57, v4 row_newbcast:12 row_mask:0xf bank_mask:0xf
    v_and_b32_dpp v25, v57, v5 row_newbcast:12 row_mask:0xf bank_mask:0xf
    v_and_b32_dpp v26, v57, v6 row_newbcast:12 row_mask:0xf bank_mask:0xf
    v_and_b32_dpp v27, v57, v7 row_newbcast:12 row_mask:0xf bank_mask:0xf
    v_mfma_f32_16x16x32_bf16 v[28:31], v[20:23], a[184:187], v[28:31]
    v_and_b32_dpp v20, v58, v4 row_newbcast:0 row_mask:0xf bank_mask:0xf
    v_and_b32_dpp v21, v58, v5 row_newbcast:0 row_mask:0xf bank_mask:0xf
    v_and_b32_dpp v22, v58, v6 row_newbcast:0 row_mask:0xf bank_mask:0xf
    v_and_b32_dpp v23, v58, v7 row_newbcast:0 row_mask:0xf bank_mask:0xf
    v_mfma_f32_16x16x32_bf16 v[28:31], v[24:27], a[188:191], v[28:31]
    v_and_b32_dpp v24, v58, v4 row_newbcast:4 row_mask:0xf bank_mask:0xf
    v_and_b32_dpp v25, v58, v5 row_newbcast:4 row_mask:0xf bank_mask:0xf
    v_and_b32_dpp v26, v58, v6 row_newbcast:4 row_mask:0xf bank_mask:0xf
    v_and_b32_dpp v27, v58, v7 row_newbcast:4 row_mask:0xf bank_mask:0xf
    v_mfma_f32_16x16x32_bf16 v[28:31], v[20:23], a[192:195], v[28:31]
    v_and_b32_dpp v20, v58, v4 row_newbcast:8 row_mask:0xf bank_mask:0xf
    v_and_b32_dpp v21, v58, v5 row_newbcast:8 row_mask:0xf bank_mask:0xf
    v_and_b32_dpp v22, v58, v6 row_newbcast:8 row_mask:0xf bank_mask:0xf
    v_and_b32_dpp v23, v58, v7 row_newbcast:8 row_mask:0xf bank_mask:0xf
    v_mfma_f32_16x16x32_bf16 v[28:31], v[24:27], a[196:199], v[28:31]
    v_and_b32_dpp v24, v58, v4 row_newbcast:12 row_mask:0xf bank_mask:0xf
    v_and_b32_dpp v25, v58, v5 row_newbcast:12 row_mask:0xf bank_mask:0xf
    v_and_b32_dpp v26, v58, v6 row_newbcast:12 row_mask:0xf bank_mask:0xf
    v_and_b32_dpp v27, v58, v7 row_newbcast:12 row_mask:0xf bank_mask:0xf
    v_mfma_f32_16x16x32_bf16 v[28:31], v[20:23], a[200:203], v[28:31]
    v_and_b32_dpp v20, v59, v4 row_newbcast:0 row_mask:0xf bank_mask:0xf
    v_and_b32_dpp v21, v59, v5 row_newbcast:0 row_mask:0xf bank_mask:0xf
    v_and_b32_dpp v22, v59, v6 row_newbcast:0 row_mask:0xf bank_mask:0xf
    v_and_b32_dpp v23, v59, v7 row_newbcast:0 row_mask:0xf bank_mask:0xf
    v_mfma_f32_16x16x32_bf16 v[28:31], v[24:27], a[204:207], v[28:31]
    v_and_b32_dpp v24, v59, v4 row_newbcast:4 row_mask:0xf bank_mask:0xf
    v_and_b32_dpp v25, v59, v5 row_newbcast:4 row_mask:0xf bank_mask:0xf
    v_and_b32_dpp v26, v59, v6 row_newbcast:4 row_mask:0xf bank_mask:0xf
    v_and_b32_dpp v27, v59, v7 row_newbcast:4 row_mask:0xf bank_mask:0xf
    v_mfma_f32_16x16x32_bf16 v[28:31], v[20:23], a[208:211], v[28:31]
    s_mov_b32 s24, 0
recurrent_scan__gqa_block_cached__dense_activation_silu__decode_kernel_mlchk:
    v_xor_b32 v112, s73, v65
    v_xor_b32 v113, s74, v67
    v_or_b32 v112, v112, v113
    v_cmp_ne_u32 vcc, 0, v112
    s_add_u32 s24, s24, 1
    s_cbranch_vccz recurrent_scan__gqa_block_cached__dense_activation_silu__decode_kernel_mlok
    s_cmp_ge_u32 s24, 0x40000
    s_cbranch_scc1 recurrent_scan__gqa_block_cached__dense_activation_silu__decode_kernel_mlok
    buffer_load_dwordx4 v[64:67], v105, s[32:35], 0 offen sc0 sc1
    s_waitcnt vmcnt(0)
    s_branch recurrent_scan__gqa_block_cached__dense_activation_silu__decode_kernel_mlchk
recurrent_scan__gqa_block_cached__dense_activation_silu__decode_kernel_mlok:
    v_mov_b32 v112, v64
    s_nop 1
    v_max_f32_dpp v112, v112, v112 quad_perm:[1,0,3,2] row_mask:0xf bank_mask:0xf
    s_nop 1
    v_max_f32_dpp v112, v112, v112 quad_perm:[2,3,0,1] row_mask:0xf bank_mask:0xf
    s_nop 1
    v_max_f32_dpp v112, v112, v112 row_half_mirror row_mask:0xf bank_mask:0xf
    s_nop 1
    v_max_f32_dpp v112, v112, v112 row_mirror row_mask:0xf bank_mask:0xf
    v_mov_b32 v115, v112
    s_nop 1
    v_permlane16_swap_b32 v112, v115
    s_nop 0
    v_max_f32 v112, v112, v115
    v_sub_f32 v113, v64, v112
    v_sub_f32 v62, v12, v112
    v_mul_f32 v113, 0x3fb8aa3b, v113
    v_mul_f32 v62, 0x3fb8aa3b, v62
    v_exp_f32 v113, v113
    v_exp_f32 v62, v62
    s_nop 0
    v_mul_f32 v114, v113, v66
    s_nop 1
    v_add_f32_dpp v114, v114, v114 quad_perm:[1,0,3,2] row_mask:0xf bank_mask:0xf
    s_nop 1
    v_add_f32_dpp v114, v114, v114 quad_perm:[2,3,0,1] row_mask:0xf bank_mask:0xf
    s_nop 1
    v_add_f32_dpp v114, v114, v114 row_half_mirror row_mask:0xf bank_mask:0xf
    s_nop 1
    v_add_f32_dpp v114, v114, v114 row_mirror row_mask:0xf bank_mask:0xf
    v_mov_b32 v115, v114
    s_nop 1
    v_permlane16_swap_b32 v114, v115
    s_nop 0
    v_add_f32 v114, v114, v115
    v_rcp_f32 v115, v114
    s_nop 0
    v_mul_f32 v112, v62, v115
    v_fma_f32 v113, -v112, v114, v62
    v_fma_f32 v62, v113, v115, v112
    v_and_b32_dpp v20, v59, v4 row_newbcast:8 row_mask:0xf bank_mask:0xf
    v_and_b32_dpp v21, v59, v5 row_newbcast:8 row_mask:0xf bank_mask:0xf
    v_and_b32_dpp v22, v59, v6 row_newbcast:8 row_mask:0xf bank_mask:0xf
    v_and_b32_dpp v23, v59, v7 row_newbcast:8 row_mask:0xf bank_mask:0xf
    v_mfma_f32_16x16x32_bf16 v[28:31], v[24:27], a[212:215], v[28:31]
    v_and_b32_dpp v24, v59, v4 row_newbcast:12 row_mask:0xf bank_mask:0xf
    v_and_b32_dpp v25, v59, v5 row_newbcast:12 row_mask:0xf bank_mask:0xf
    v_and_b32_dpp v26, v59, v6 row_newbcast:12 row_mask:0xf bank_mask:0xf
    v_and_b32_dpp v27, v59, v7 row_newbcast:12 row_mask:0xf bank_mask:0xf
    v_mfma_f32_16x16x32_bf16 v[28:31], v[20:23], a[216:219], v[28:31]
    v_and_b32_dpp v20, v60, v4 row_newbcast:0 row_mask:0xf bank_mask:0xf
    v_and_b32_dpp v21, v60, v5 row_newbcast:0 row_mask:0xf bank_mask:0xf
    v_and_b32_dpp v22, v60, v6 row_newbcast:0 row_mask:0xf bank_mask:0xf
    v_and_b32_dpp v23, v60, v7 row_newbcast:0 row_mask:0xf bank_mask:0xf
    v_mfma_f32_16x16x32_bf16 v[28:31], v[24:27], a[220:223], v[28:31]
    v_and_b32_dpp v24, v60, v4 row_newbcast:4 row_mask:0xf bank_mask:0xf
    v_and_b32_dpp v25, v60, v5 row_newbcast:4 row_mask:0xf bank_mask:0xf
    v_and_b32_dpp v26, v60, v6 row_newbcast:4 row_mask:0xf bank_mask:0xf
    v_and_b32_dpp v27, v60, v7 row_newbcast:4 row_mask:0xf bank_mask:0xf
    s_waitcnt vmcnt(7)
    v_mfma_f32_16x16x32_bf16 v[28:31], v[20:23], a[224:227], v[28:31]
    v_and_b32_dpp v20, v60, v4 row_newbcast:8 row_mask:0xf bank_mask:0xf
    v_and_b32_dpp v21, v60, v5 row_newbcast:8 row_mask:0xf bank_mask:0xf
    v_and_b32_dpp v22, v60, v6 row_newbcast:8 row_mask:0xf bank_mask:0xf
    v_and_b32_dpp v23, v60, v7 row_newbcast:8 row_mask:0xf bank_mask:0xf
    s_waitcnt vmcnt(6)
    v_mfma_f32_16x16x32_bf16 v[28:31], v[24:27], a[228:231], v[28:31]
    v_and_b32_dpp v24, v60, v4 row_newbcast:12 row_mask:0xf bank_mask:0xf
    v_and_b32_dpp v25, v60, v5 row_newbcast:12 row_mask:0xf bank_mask:0xf
    v_and_b32_dpp v26, v60, v6 row_newbcast:12 row_mask:0xf bank_mask:0xf
    v_and_b32_dpp v27, v60, v7 row_newbcast:12 row_mask:0xf bank_mask:0xf
    s_waitcnt vmcnt(5)
    v_mfma_f32_16x16x32_bf16 v[28:31], v[20:23], a[232:235], v[28:31]
    v_and_b32_dpp v20, v61, v4 row_newbcast:0 row_mask:0xf bank_mask:0xf
    v_and_b32_dpp v21, v61, v5 row_newbcast:0 row_mask:0xf bank_mask:0xf
    v_and_b32_dpp v22, v61, v6 row_newbcast:0 row_mask:0xf bank_mask:0xf
    v_and_b32_dpp v23, v61, v7 row_newbcast:0 row_mask:0xf bank_mask:0xf
    s_waitcnt vmcnt(4)
    v_mfma_f32_16x16x32_bf16 v[28:31], v[24:27], a[236:239], v[28:31]
    v_and_b32_dpp v24, v61, v4 row_newbcast:4 row_mask:0xf bank_mask:0xf
    v_and_b32_dpp v25, v61, v5 row_newbcast:4 row_mask:0xf bank_mask:0xf
    v_and_b32_dpp v26, v61, v6 row_newbcast:4 row_mask:0xf bank_mask:0xf
    v_and_b32_dpp v27, v61, v7 row_newbcast:4 row_mask:0xf bank_mask:0xf
    s_waitcnt vmcnt(3)
    v_mfma_f32_16x16x32_bf16 v[28:31], v[20:23], a[240:243], v[28:31]
    v_and_b32_dpp v20, v61, v4 row_newbcast:8 row_mask:0xf bank_mask:0xf
    v_and_b32_dpp v21, v61, v5 row_newbcast:8 row_mask:0xf bank_mask:0xf
    v_and_b32_dpp v22, v61, v6 row_newbcast:8 row_mask:0xf bank_mask:0xf
    v_and_b32_dpp v23, v61, v7 row_newbcast:8 row_mask:0xf bank_mask:0xf
    s_waitcnt vmcnt(2)
    v_mfma_f32_16x16x32_bf16 v[28:31], v[24:27], a[244:247], v[28:31]
    v_and_b32_dpp v24, v61, v4 row_newbcast:12 row_mask:0xf bank_mask:0xf
    v_and_b32_dpp v25, v61, v5 row_newbcast:12 row_mask:0xf bank_mask:0xf
    v_and_b32_dpp v26, v61, v6 row_newbcast:12 row_mask:0xf bank_mask:0xf
    v_and_b32_dpp v27, v61, v7 row_newbcast:12 row_mask:0xf bank_mask:0xf
    s_waitcnt vmcnt(1)
    v_mfma_f32_16x16x32_bf16 v[28:31], v[20:23], a[248:251], v[28:31]
    s_nop 1
    s_waitcnt vmcnt(0)
    v_mfma_f32_16x16x32_bf16 v[28:31], v[24:27], a[252:255], v[28:31]
    s_nop 7
    ds_write_b128 v40, v[28:31] offset:16384
    s_waitcnt lgkmcnt(0)
    s_barrier
    ds_read_b64 v[112:113], v41 offset:16384
    ds_read_b64 v[114:115], v41 offset:16896
    ds_read_b64 v[116:117], v41 offset:17408
    ds_read_b64 v[118:119], v41 offset:17920
    s_waitcnt lgkmcnt(0)
    v_add_f32 v112, v112, v114
    v_add_f32 v113, v113, v115
    v_add_f32 v116, v116, v118
    v_add_f32 v117, v117, v119
    v_add_f32 v112, v112, v116
    v_add_f32 v113, v113, v117
    v_cvt_pk_bf16_f32 v112, v112, v112
    v_cvt_pk_bf16_f32 v113, v113, v113
    ds_write_b64 v33, v[112:113] offset:18432
    s_waitcnt lgkmcnt(0)
    ds_read_b128 v[46:49], v34 offset:18432
    ds_read_b128 v[50:53], v34 offset:18448
    ds_read_b128 v[54:57], v34 offset:18464
    ds_read_b128 v[58:61], v34 offset:18480
    ds_read_b128 v[112:115], v34 offset:18496
    ds_read_b128 v[116:119], v34 offset:18512
    ds_read_b128 v[120:123], v34 offset:18528
    ds_read_b128 v[124:127], v34 offset:18544
    s_waitcnt lgkmcnt(7)
    v_and_b32 v20, v4, v46
    v_and_b32 v21, v5, v46
    v_and_b32 v22, v6, v46
    v_and_b32 v23, v7, v46
    v_and_b32 v24, v4, v47
    v_and_b32 v25, v5, v47
    v_and_b32 v26, v6, v47
    v_and_b32 v27, v7, v47
    v_mfma_f32_16x16x32_bf16 v[28:31], v[20:23], v[128:131], 0
    v_and_b32 v20, v4, v48
    v_and_b32 v21, v5, v48
    v_and_b32 v22, v6, v48
    v_and_b32 v23, v7, v48
    v_mfma_f32_16x16x32_bf16 v[28:31], v[24:27], v[132:135], v[28:31]
    v_and_b32 v24, v4, v49
    v_and_b32 v25, v5, v49
    v_and_b32 v26, v6, v49
    v_and_b32 v27, v7, v49
    v_mfma_f32_16x16x32_bf16 v[28:31], v[20:23], v[136:139], v[28:31]
    s_waitcnt lgkmcnt(6)
    v_and_b32 v20, v4, v50
    v_and_b32 v21, v5, v50
    v_and_b32 v22, v6, v50
    v_and_b32 v23, v7, v50
    v_mfma_f32_16x16x32_bf16 v[28:31], v[24:27], v[140:143], v[28:31]
    v_and_b32 v24, v4, v51
    v_and_b32 v25, v5, v51
    v_and_b32 v26, v6, v51
    v_and_b32 v27, v7, v51
    v_mfma_f32_16x16x32_bf16 v[28:31], v[20:23], v[144:147], v[28:31]
    v_and_b32 v20, v4, v52
    v_and_b32 v21, v5, v52
    v_and_b32 v22, v6, v52
    v_and_b32 v23, v7, v52
    v_mfma_f32_16x16x32_bf16 v[28:31], v[24:27], v[148:151], v[28:31]
    v_and_b32 v24, v4, v53
    v_and_b32 v25, v5, v53
    v_and_b32 v26, v6, v53
    v_and_b32 v27, v7, v53
    v_mfma_f32_16x16x32_bf16 v[28:31], v[20:23], v[152:155], v[28:31]
    s_waitcnt lgkmcnt(5)
    v_and_b32 v20, v4, v54
    v_and_b32 v21, v5, v54
    v_and_b32 v22, v6, v54
    v_and_b32 v23, v7, v54
    v_mfma_f32_16x16x32_bf16 v[28:31], v[24:27], v[156:159], v[28:31]
    v_and_b32 v24, v4, v55
    v_and_b32 v25, v5, v55
    v_and_b32 v26, v6, v55
    v_and_b32 v27, v7, v55
    v_mfma_f32_16x16x32_bf16 v[28:31], v[20:23], v[160:163], v[28:31]
    v_and_b32 v20, v4, v56
    v_and_b32 v21, v5, v56
    v_and_b32 v22, v6, v56
    v_and_b32 v23, v7, v56
    v_mfma_f32_16x16x32_bf16 v[28:31], v[24:27], v[164:167], v[28:31]
    v_and_b32 v24, v4, v57
    v_and_b32 v25, v5, v57
    v_and_b32 v26, v6, v57
    v_and_b32 v27, v7, v57
    v_mfma_f32_16x16x32_bf16 v[28:31], v[20:23], v[168:171], v[28:31]
    s_waitcnt lgkmcnt(4)
    v_and_b32 v20, v4, v58
    v_and_b32 v21, v5, v58
    v_and_b32 v22, v6, v58
    v_and_b32 v23, v7, v58
    v_mfma_f32_16x16x32_bf16 v[28:31], v[24:27], v[172:175], v[28:31]
    v_and_b32 v24, v4, v59
    v_and_b32 v25, v5, v59
    v_and_b32 v26, v6, v59
    v_and_b32 v27, v7, v59
    v_mfma_f32_16x16x32_bf16 v[28:31], v[20:23], v[176:179], v[28:31]
    v_and_b32 v20, v4, v60
    v_and_b32 v21, v5, v60
    v_and_b32 v22, v6, v60
    v_and_b32 v23, v7, v60
    v_mfma_f32_16x16x32_bf16 v[28:31], v[24:27], v[180:183], v[28:31]
    v_and_b32 v24, v4, v61
    v_and_b32 v25, v5, v61
    v_and_b32 v26, v6, v61
    v_and_b32 v27, v7, v61
    v_mfma_f32_16x16x32_bf16 v[28:31], v[20:23], v[184:187], v[28:31]
    s_waitcnt lgkmcnt(3)
    v_and_b32 v20, v4, v112
    v_and_b32 v21, v5, v112
    v_and_b32 v22, v6, v112
    v_and_b32 v23, v7, v112
    v_mfma_f32_16x16x32_bf16 v[28:31], v[24:27], v[188:191], v[28:31]
    v_and_b32 v24, v4, v113
    v_and_b32 v25, v5, v113
    v_and_b32 v26, v6, v113
    v_and_b32 v27, v7, v113
    v_mfma_f32_16x16x32_bf16 v[28:31], v[20:23], v[192:195], v[28:31]
    v_and_b32 v20, v4, v114
    v_and_b32 v21, v5, v114
    v_and_b32 v22, v6, v114
    v_and_b32 v23, v7, v114
    v_mfma_f32_16x16x32_bf16 v[28:31], v[24:27], v[196:199], v[28:31]
    v_and_b32 v24, v4, v115
    v_and_b32 v25, v5, v115
    v_and_b32 v26, v6, v115
    v_and_b32 v27, v7, v115
    v_mfma_f32_16x16x32_bf16 v[28:31], v[20:23], v[200:203], v[28:31]
    s_waitcnt lgkmcnt(2)
    v_and_b32 v20, v4, v116
    v_and_b32 v21, v5, v116
    v_and_b32 v22, v6, v116
    v_and_b32 v23, v7, v116
    v_mfma_f32_16x16x32_bf16 v[28:31], v[24:27], v[204:207], v[28:31]
    v_and_b32 v24, v4, v117
    v_and_b32 v25, v5, v117
    v_and_b32 v26, v6, v117
    v_and_b32 v27, v7, v117
    v_mfma_f32_16x16x32_bf16 v[28:31], v[20:23], v[208:211], v[28:31]
    v_and_b32 v20, v4, v118
    v_and_b32 v21, v5, v118
    v_and_b32 v22, v6, v118
    v_and_b32 v23, v7, v118
    v_mfma_f32_16x16x32_bf16 v[28:31], v[24:27], v[212:215], v[28:31]
    v_and_b32 v24, v4, v119
    v_and_b32 v25, v5, v119
    v_and_b32 v26, v6, v119
    v_and_b32 v27, v7, v119
    v_mfma_f32_16x16x32_bf16 v[28:31], v[20:23], v[216:219], v[28:31]
    s_waitcnt lgkmcnt(1)
    v_and_b32 v20, v4, v120
    v_and_b32 v21, v5, v120
    v_and_b32 v22, v6, v120
    v_and_b32 v23, v7, v120
    v_mfma_f32_16x16x32_bf16 v[28:31], v[24:27], v[220:223], v[28:31]
    v_and_b32 v24, v4, v121
    v_and_b32 v25, v5, v121
    v_and_b32 v26, v6, v121
    v_and_b32 v27, v7, v121
    v_mfma_f32_16x16x32_bf16 v[28:31], v[20:23], v[224:227], v[28:31]
    v_and_b32 v20, v4, v122
    v_and_b32 v21, v5, v122
    v_and_b32 v22, v6, v122
    v_and_b32 v23, v7, v122
    v_mfma_f32_16x16x32_bf16 v[28:31], v[24:27], v[228:231], v[28:31]
    v_and_b32 v24, v4, v123
    v_and_b32 v25, v5, v123
    v_and_b32 v26, v6, v123
    v_and_b32 v27, v7, v123
    v_mfma_f32_16x16x32_bf16 v[28:31], v[20:23], v[232:235], v[28:31]
    s_waitcnt lgkmcnt(0)
    v_and_b32 v20, v4, v124
    v_and_b32 v21, v5, v124
    v_and_b32 v22, v6, v124
    v_and_b32 v23, v7, v124
    v_mfma_f32_16x16x32_bf16 v[28:31], v[24:27], v[236:239], v[28:31]
    v_and_b32 v24, v4, v125
    v_and_b32 v25, v5, v125
    v_and_b32 v26, v6, v125
    v_and_b32 v27, v7, v125
    v_mfma_f32_16x16x32_bf16 v[28:31], v[20:23], v[240:243], v[28:31]
    v_and_b32 v20, v4, v126
    v_and_b32 v21, v5, v126
    v_and_b32 v22, v6, v126
    v_and_b32 v23, v7, v126
    v_mfma_f32_16x16x32_bf16 v[28:31], v[24:27], v[244:247], v[28:31]
    v_and_b32 v24, v4, v127
    v_and_b32 v25, v5, v127
    v_and_b32 v26, v6, v127
    v_and_b32 v27, v7, v127
    v_mfma_f32_16x16x32_bf16 v[28:31], v[20:23], v[248:251], v[28:31]
    s_nop 1
    v_mfma_f32_16x16x32_bf16 v[28:31], v[24:27], v[252:255], v[28:31]
    s_waitcnt vmcnt(0)
    s_nop 7
    v_cndmask_b32 v36, v30, v28, s[96:97]
    v_cndmask_b32 v38, v31, v29, s[96:97]
    v_mul_f32 v36, v36, v62
    v_mul_f32 v38, v38, v62
    buffer_store_dwordx4 v[36:39], v42, s[56:59], 0 offen sc0 sc1
    s_sub_u32 s21, s2, 224
    s_cmp_ge_u32 s21, 32
    s_cbranch_scc1 recurrent_scan__gqa_block_cached__dense_activation_silu__decode_kernel_fin
    s_lshl_b32 s26, s21, 7
    s_add_u32 s27, s26, 32768
    s_sub_u32 s24, 1048576, s26
    s_add_u32 s56, s14, s27
    s_addc_u32 s57, s15, 0
    s_mov_b32 s58, s24
    s_mov_b32 s59, 0x00020000
    s_lshl_b32 s27, s21, 5
    s_add_u32 s36, s4, s27
    s_addc_u32 s37, s5, 0
    s_mov_b32 s38, 32
    s_mov_b32 s39, 0x00020000
    s_add_u32 s40, s70, s27
    s_addc_u32 s41, s71, 0
    s_mov_b32 s42, 32
    s_mov_b32 s43, 0x00020000
    v_and_b32 v34, 15, v1
    v_lshlrev_b32 v34, 1, v34
    buffer_load_ushort v107, v34, s[36:39], 0 offen
    s_mov_b32 s24, 0
recurrent_scan__gqa_block_cached__dense_activation_silu__decode_kernel_gchk:
    v_xor_b32 v32, s73, v69
    v_xor_b32 v33, s74, v71
    v_or_b32 v106, v32, v33
    v_xor_b32 v32, s73, v73
    v_xor_b32 v33, s74, v75
    v_or3_b32 v106, v106, v32, v33
    v_xor_b32 v32, s73, v77
    v_xor_b32 v33, s74, v79
    v_or3_b32 v106, v106, v32, v33
    v_xor_b32 v32, s73, v81
    v_xor_b32 v33, s74, v83
    v_or3_b32 v106, v106, v32, v33
    v_xor_b32 v32, s73, v85
    v_xor_b32 v33, s74, v87
    v_or3_b32 v106, v106, v32, v33
    v_xor_b32 v32, s73, v89
    v_xor_b32 v33, s74, v91
    v_or_b32 v32, v32, v33
    v_and_or_b32 v106, v32, v108, v106
    v_cmp_ne_u32 vcc, 0, v106
    s_add_u32 s24, s24, 1
    s_cbranch_vccz recurrent_scan__gqa_block_cached__dense_activation_silu__decode_kernel_gok
    s_cmp_ge_u32 s24, 0x40000
    s_cbranch_scc1 recurrent_scan__gqa_block_cached__dense_activation_silu__decode_kernel_gok
    s_mov_b32 s26, 0
    buffer_load_dwordx4 v[68:71], v104, s[48:51], s26 offen sc0 sc1
    s_mov_b32 s26, 131072
    buffer_load_dwordx4 v[72:75], v104, s[48:51], s26 offen sc0 sc1
    s_mov_b32 s26, 262144
    buffer_load_dwordx4 v[76:79], v104, s[48:51], s26 offen sc0 sc1
    s_mov_b32 s26, 393216
    buffer_load_dwordx4 v[80:83], v104, s[48:51], s26 offen sc0 sc1
    s_mov_b32 s26, 524288
    buffer_load_dwordx4 v[84:87], v104, s[48:51], s26 offen sc0 sc1
    s_mov_b32 s26, 655360
    buffer_load_dwordx4 v[88:91], v104, s[48:51], s26 offen sc0 sc1
    s_waitcnt vmcnt(0)
    s_branch recurrent_scan__gqa_block_cached__dense_activation_silu__decode_kernel_gchk
recurrent_scan__gqa_block_cached__dense_activation_silu__decode_kernel_gok:
    s_mov_b32 s26, 0
    buffer_load_dwordx4 v[128:131], v104, s[56:59], s26 offen sc0 sc1
    s_mov_b32 s26, 131072
    buffer_load_dwordx4 v[132:135], v104, s[56:59], s26 offen sc0 sc1
    s_mov_b32 s26, 262144
    buffer_load_dwordx4 v[136:139], v104, s[56:59], s26 offen sc0 sc1
    s_mov_b32 s26, 393216
    buffer_load_dwordx4 v[140:143], v104, s[56:59], s26 offen sc0 sc1
    s_mov_b32 s26, 524288
    buffer_load_dwordx4 v[144:147], v104, s[56:59], s26 offen sc0 sc1
    s_mov_b32 s26, 655360
    buffer_load_dwordx4 v[148:151], v104, s[56:59], s26 offen sc0 sc1
    s_mov_b32 s26, 786432
    buffer_load_dwordx4 v[152:155], v104, s[56:59], s26 offen sc0 sc1
    s_mov_b32 s26, 917504
    buffer_load_dwordx4 v[156:159], v104, s[56:59], s26 offen sc0 sc1
    v_mov_b32 v42, v68
    v_mov_b32 v43, v70
    v_add_f32 v42, v42, v72
    v_add_f32 v43, v43, v74
    v_add_f32 v42, v42, v76
    v_add_f32 v43, v43, v78
    v_add_f32 v42, v42, v80
    v_add_f32 v43, v43, v82
    v_add_f32 v42, v42, v84
    v_add_f32 v43, v43, v86
    v_add_f32 v42, v42, v88
    v_add_f32 v43, v43, v90
    v_lshrrev_b32 v44, 5, v1
    v_and_b32 v32, 7, v1
    v_lshl_add_u32 v44, v44, 3, v32
    v_lshlrev_b32 v44, 4, v44
    s_lshl_b32 s26, s3, 2
    v_add_u32 v44, s26, v44
    v_and_b32 v45, 1, v1
    v_bfe_u32 v32, v1, 1, 3
    v_lshl_add_u32 v45, v45, 3, v32
    v_lshlrev_b32 v45, 4, v45
    s_nop 1
    v_permlane32_swap_b32 v42, v43
    s_nop 0
    v_add_f32 v42, v42, v43
    v_mov_b32 v32, v42
    s_nop 1
    v_permlane16_swap_b32 v42, v32
    s_nop 0
    v_add_f32 v42, v42, v32
    s_nop 1
    v_add_f32_dpp v42, v42, v42 row_ror:8 row_mask:0xf bank_mask:0xf
    ds_write_b32 v44, v42 offset:5248
    s_waitcnt lgkmcnt(0)
    s_barrier
    ds_read_b128 v[48:51], v45 offset:5248
    s_waitcnt lgkmcnt(0)
    v_add_f32 v46, v48, v49
    v_add_f32 v50, v50, v51
    v_add_f32 v46, v46, v50
    v_cvt_pk_bf16_f32 v46, v46, v46
    v_lshlrev_b32 v46, 16, v46
    v_mul_f32 v48, 0xbfb8aa3b, v46
    v_exp_f32 v48, v48
    s_nop 0
    v_add_f32 v48, 1.0, v48
    v_rcp_f32 v49, v48
    s_nop 0
    v_mul_f32 v50, v46, v49
    v_fma_f32 v51, -v50, v48, v46
    v_fma_f32 v50, v51, v49, v50
    v_cmp_lt_f32 vcc, 0x7f000000, v48
    v_mul_f32 v51, v46, v49
    s_nop 0
    v_cndmask_b32 v46, v50, v51, vcc
    v_cvt_pk_bf16_f32 v46, v46, v46
    v_lshlrev_b32 v46, 16, v46
    s_mov_b64 s[64:65], -1
    s_mov_b32 s24, 0
recurrent_scan__gqa_block_cached__dense_activation_silu__decode_kernel_poll:
    s_mov_b32 s26, 0
    buffer_load_dwordx4 v[160:163], v104, s[56:59], s26 offen sc0 sc1
    s_mov_b32 s26, 131072
    buffer_load_dwordx4 v[164:167], v104, s[56:59], s26 offen sc0 sc1
    s_mov_b32 s26, 262144
    buffer_load_dwordx4 v[168:171], v104, s[56:59], s26 offen sc0 sc1
    s_mov_b32 s26, 393216
    buffer_load_dwordx4 v[172:175], v104, s[56:59], s26 offen sc0 sc1
    s_mov_b32 s26, 524288
    buffer_load_dwordx4 v[176:179], v104, s[56:59], s26 offen sc0 sc1
    s_mov_b32 s26, 655360
    buffer_load_dwordx4 v[180:183], v104, s[56:59], s26 offen sc0 sc1
    s_mov_b32 s26, 786432
    buffer_load_dwordx4 v[184:187], v104, s[56:59], s26 offen sc0 sc1
    s_mov_b32 s26, 917504
    buffer_load_dwordx4 v[188:191], v104, s[56:59], s26 offen sc0 sc1
    s_waitcnt vmcnt(8)
    v_xor_b32 v32, s73, v129
    v_xor_b32 v33, s74, v131
    v_or_b32 v106, v32, v33
    v_xor_b32 v32, s73, v133
    v_xor_b32 v33, s74, v135
    v_or3_b32 v106, v106, v32, v33
    v_xor_b32 v32, s73, v137
    v_xor_b32 v33, s74, v139
    v_or3_b32 v106, v106, v32, v33
    v_xor_b32 v32, s73, v141
    v_xor_b32 v33, s74, v143
    v_or3_b32 v106, v106, v32, v33
    v_xor_b32 v32, s73, v145
    v_xor_b32 v33, s74, v147
    v_or3_b32 v106, v106, v32, v33
    v_xor_b32 v32, s73, v149
    v_xor_b32 v33, s74, v151
    v_or3_b32 v106, v106, v32, v33
    v_xor_b32 v32, s73, v153
    v_xor_b32 v33, s74, v155
    v_or3_b32 v106, v106, v32, v33
    v_xor_b32 v32, s73, v157
    v_xor_b32 v33, s74, v159
    v_or3_b32 v106, v106, v32, v33
    v_cmp_ne_u32 vcc, 0, v106
    s_andn2_b64 s[66:67], exec, vcc
    s_and_b64 s[64:65], exec, vcc
    s_mov_b64 exec, s[66:67]
    v_add_f32 v40, v128, v132
    v_add_f32 v41, v130, v134
    v_add_f32 v40, v40, v136
    v_add_f32 v41, v41, v138
    v_add_f32 v40, v40, v140
    v_add_f32 v41, v41, v142
    v_add_f32 v40, v40, v144
    v_add_f32 v41, v41, v146
    v_add_f32 v40, v40, v148
    v_add_f32 v41, v41, v150
    v_add_f32 v40, v40, v152
    v_add_f32 v41, v41, v154
    v_add_f32 v40, v40, v156
    v_add_f32 v41, v41, v158
    s_cmp_eq_u64 s[64:65], 0
    s_cbranch_scc1 recurrent_scan__gqa_block_cached__dense_activation_silu__decode_kernel_got
    s_mov_b64 exec, s[64:65]
    s_mov_b32 s26, 0
    buffer_load_dwordx4 v[128:131], v104, s[56:59], s26 offen sc0 sc1
    s_mov_b32 s26, 131072
    buffer_load_dwordx4 v[132:135], v104, s[56:59], s26 offen sc0 sc1
    s_mov_b32 s26, 262144
    buffer_load_dwordx4 v[136:139], v104, s[56:59], s26 offen sc0 sc1
    s_mov_b32 s26, 393216
    buffer_load_dwordx4 v[140:143], v104, s[56:59], s26 offen sc0 sc1
    s_mov_b32 s26, 524288
    buffer_load_dwordx4 v[144:147], v104, s[56:59], s26 offen sc0 sc1
    s_mov_b32 s26, 655360
    buffer_load_dwordx4 v[148:151], v104, s[56:59], s26 offen sc0 sc1
    s_mov_b32 s26, 786432
    buffer_load_dwordx4 v[152:155], v104, s[56:59], s26 offen sc0 sc1
    s_mov_b32 s26, 917504
    buffer_load_dwordx4 v[156:159], v104, s[56:59], s26 offen sc0 sc1
    s_waitcnt vmcnt(8)
    v_xor_b32 v32, s73, v161
    v_xor_b32 v33, s74, v163
    v_or_b32 v106, v32, v33
    v_xor_b32 v32, s73, v165
    v_xor_b32 v33, s74, v167
    v_or3_b32 v106, v106, v32, v33
    v_xor_b32 v32, s73, v169
    v_xor_b32 v33, s74, v171
    v_or3_b32 v106, v106, v32, v33
    v_xor_b32 v32, s73, v173
    v_xor_b32 v33, s74, v175
    v_or3_b32 v106, v106, v32, v33
    v_xor_b32 v32, s73, v177
    v_xor_b32 v33, s74, v179
    v_or3_b32 v106, v106, v32, v33
    v_xor_b32 v32, s73, v181
    v_xor_b32 v33, s74, v183
    v_or3_b32 v106, v106, v32, v33
    v_xor_b32 v32, s73, v185
    v_xor_b32 v33, s74, v187
    v_or3_b32 v106, v106, v32, v33
    v_xor_b32 v32, s73, v189
    v_xor_b32 v33, s74, v191
    v_or3_b32 v106, v106, v32, v33
    v_cmp_ne_u32 vcc, 0, v106
    s_andn2_b64 s[66:67], exec, vcc
    s_and_b64 s[64:65], exec, vcc
    s_mov_b64 exec, s[66:67]
    v_add_f32 v40, v160, v164
    v_add_f32 v41, v162, v166
    v_add_f32 v40, v40, v168
    v_add_f32 v41, v41, v170
    v_add_f32 v40, v40, v172
    v_add_f32 v41, v41, v174
    v_add_f32 v40, v40, v176
    v_add_f32 v41, v41, v178
    v_add_f32 v40, v40, v180
    v_add_f32 v41, v41, v182
    v_add_f32 v40, v40, v184
    v_add_f32 v41, v41, v186
    v_add_f32 v40, v40, v188
    v_add_f32 v41, v41, v190
    s_cmp_eq_u64 s[64:65], 0
    s_cbranch_scc1 recurrent_scan__gqa_block_cached__dense_activation_silu__decode_kernel_got
    s_mov_b64 exec, s[64:65]
    s_add_u32 s24, s24, 1
    s_cmp_lt_u32 s24, 0x20000
    s_cbranch_scc1 recurrent_scan__gqa_block_cached__dense_activation_silu__decode_kernel_poll
recurrent_scan__gqa_block_cached__dense_activation_silu__decode_kernel_got:
    s_mov_b64 exec, -1
    s_nop 1
    v_permlane32_swap_b32 v40, v41
    s_nop 0
    v_add_f32 v40, v40, v41
    v_mov_b32 v32, v40
    s_nop 1
    v_permlane16_swap_b32 v40, v32
    s_nop 0
    v_add_f32 v40, v40, v32
    s_nop 1
    v_add_f32_dpp v40, v40, v40 row_ror:8 row_mask:0xf bank_mask:0xf
    ds_write_b32 v44, v40 offset:5504
    s_waitcnt lgkmcnt(0)
    s_barrier
    s_cmp_lg_u32 s3, 0
    s_cbranch_scc1 recurrent_scan__gqa_block_cached__dense_activation_silu__decode_kernel_fin
    ds_read_b128 v[36:39], v45 offset:5504
    v_lshlrev_b32 v107, 16, v107
    s_waitcnt lgkmcnt(0)
    v_add_f32 v36, v36, v37
    v_add_f32 v38, v38, v39
    v_add_f32 v36, v36, v38
    v_cvt_pk_bf16_f32 v36, v36, v36
    v_lshlrev_b32 v36, 16, v36
    v_mul_f32 v36, v36, v46
    v_cvt_pk_bf16_f32 v36, v36, v36
    v_lshlrev_b32 v36, 16, v36
    v_add_f32 v36, v36, v107
    v_cvt_pk_bf16_f32 v36, v36, v36
    v_and_b32 v34, 15, v1
    v_lshlrev_b32 v34, 1, v34
    s_mov_b32 exec_lo, 65535
    s_mov_b32 exec_hi, 0
    buffer_store_short v36, v34, s[40:43], 0 offen sc0 sc1
    s_cmp_lg_u32 s21, 0
    s_cbranch_scc1 recurrent_scan__gqa_block_cached__dense_activation_silu__decode_kernel_fin
    s_mov_b32 s27, 0
    s_add_u32 s60, s14, s27
    s_addc_u32 s61, s15, 0
    s_mov_b32 s62, 4
    s_mov_b32 s63, 0x00020000
    s_mov_b32 exec_lo, 1
    v_mov_b32 v32, s73
    v_mov_b32 v33, 0
    buffer_store_dword v32, v33, s[60:63], 0 offen sc0 sc1
recurrent_scan__gqa_block_cached__dense_activation_silu__decode_kernel_fin:
recurrent_scan__gqa_block_cached__dense_activation_silu__decode_kernel_end:
    s_endpgm
.section .rodata,"a"
.p2align 6
.amdhsa_kernel recurrent_scan__gqa_block_cached__dense_activation_silu__decode_kernel
  .amdhsa_next_free_vgpr 512
  .amdhsa_next_free_sgpr 102
  .amdhsa_accum_offset 256
  .amdhsa_group_segment_fixed_size 0
  .amdhsa_kernarg_size 88
  .amdhsa_user_sgpr_count 2
  .amdhsa_user_sgpr_kernarg_segment_ptr 1
  .amdhsa_system_sgpr_workgroup_id_x 1
.end_amdhsa_kernel
```
